```python
import torch

def _softmax(x, axis=-1):
    return torch.softmax(x, dim=axis)

def _gelu(x):
    return torch.nn.functional.gelu(x, approximate='tanh')

def _silu(x):
    return torch.nn.functional.silu(x)

def _sigmoid(x):
    return torch.sigmoid(x)

def _layernorm(x, axis=-1, eps=1e-05):
    m = x.mean(dim=axis, keepdim=True)
    v = x.var(dim=axis, keepdim=True, unbiased=False)
    return (x - m) / torch.sqrt(v + eps)

def _scatter_add(tgt, idx, src, axis=0):
    return tgt.clone().index_add_(axis, idx, src)

def _segment_sum(src, seg, n):
    out = torch.zeros((n,) + src.shape[1:], dtype=src.dtype)
    return out.index_add_(0, seg, src)

def _pad(x, pw):
    flat = tuple((v for pair in reversed(pw) for v in pair))
    return torch.nn.functional.pad(x, flat)
kernel_name = 'adaLN_cond__sliding_block_cached__glu_gated_bilinear__decode'

def setup_inputs():

    _w = lambda a: (lambda t: t.to(torch.bfloat16) if t.is_floating_point() else t)(torch.as_tensor(a))

    def _A_setup():
        B, Sq, D = (1, 1, 512)
        Hq, Hkv, Sk, Dh = (32, 8, 32768, 128)
        assert Hq % Hkv == 0, (Hq, Hkv)
        return {'x': _w((lambda *s: torch.randn(*s, dtype=torch.bfloat16) * 0.05)(B, Sq, D)), 'k_cache': _w((lambda *s: torch.randn(*s, dtype=torch.bfloat16) * 0.8)(B, Hkv, Sk, Dh)), 'v_cache': _w((lambda *s: torch.randn(*s, dtype=torch.bfloat16) * 3.2)(B, Hkv, Sk, Dh)), 'wq': _w((lambda *s: torch.randn(*s, dtype=torch.bfloat16) * 0.8)(D, Hq * Dh) * D ** (-0.5)), 'wo': _w((lambda *s: torch.randn(*s, dtype=torch.bfloat16) * 3.2)(Hq * Dh, D) * (Hq * Dh) ** (-0.5))}
    _A_in = _A_setup()

    def _B_setup():
        B, S, D, F = (1, 1, 512, 1792)
        return {'x': _w((lambda *s: torch.randn(*s, dtype=torch.bfloat16) * 0.05)(B, S, D)), 'w_gate': _w((lambda *s: torch.randn(*s, dtype=torch.bfloat16) * 3.2)(D, F) * D ** (-0.5)), 'w_up': _w((lambda *s: torch.randn(*s, dtype=torch.bfloat16) * 3.2)(D, F) * D ** (-0.5)), 'w_down': _w((lambda *s: torch.randn(*s, dtype=torch.bfloat16) * 3.2)(F, D) * F ** (-0.5))}
    _B_in = _B_setup()
    return {'A_x': _A_in['x'], 'A_k_cache': _A_in['k_cache'], 'A_v_cache': _A_in['v_cache'], 'A_wq': _A_in['wq'], 'A_wo': _A_in['wo'], 'B_x': _B_in['x'], 'B_w_gate': _B_in['w_gate'], 'B_w_up': _B_in['w_up'], 'B_w_down': _B_in['w_down'], 'c': _w((lambda *s: torch.randn(*s, dtype=torch.bfloat16) * 0.4)(1, 512) * 8.0), 'w_mod': _w((lambda *s: torch.randn(*s, dtype=torch.bfloat16) * 0.4)(512, 6 * 512) * 512 ** (-0.5) * 8.0)}

def reference(A_x, A_k_cache, A_v_cache, A_wq, A_wo, B_x, B_w_gate, B_w_up, B_w_down, c, w_mod):

    def _A_ref(x, k_cache, v_cache, wq, wo):
        B, Sq, D = x.shape
        Hq, Dh = (32, 128)
        Hkv, Sk = (k_cache.shape[1], k_cache.shape[2])
        W = min(4096, max(256, Sk // 4))
        rep = Hq // Hkv
        q = (lambda x, *d: x.permute(*d))((x @ wq).reshape(B, Sq, Hq, Dh), 0, 2, 1, 3)
        k = (lambda x, n, axis: torch.repeat_interleave(x, n, dim=axis))(k_cache[:, :, Sk - W:, :], rep, axis=1)
        v = (lambda x, n, axis: torch.repeat_interleave(x, n, dim=axis))(v_cache[:, :, Sk - W:, :], rep, axis=1)
        scores = torch.einsum('bhqd,bhkd->bhqk', q, k) * Dh ** (-0.5)
        p = _softmax(scores, axis=-1)
        o = torch.einsum('bhqk,bhkd->bhqd', p, v)
        return (lambda x, *d: x.permute(*d))(o, 0, 2, 1, 3).reshape(B, Sq, Hq * Dh) @ wo

    def _B_ref(x, w_gate, w_up, w_down):
        g = torch.einsum('bsd,df->bsf', x, w_gate)
        u = torch.einsum('bsd,df->bsf', x, w_up)
        h = g * u
        return torch.einsum('bsf,fd->bsd', h, w_down)
    x = A_x
    mod = (_silu(c) @ w_mod).reshape(c.shape[0], 6, 1, -1)
    sa, ca, ga, sb, cb, gb = (mod[:, 0].clone(), mod[:, 1].clone(), mod[:, 2].clone(), mod[:, 3].clone(), mod[:, 4].clone(), mod[:, 5].clone())
    h = _layernorm(x, axis=-1) * (1 + ca) + sa
    x = x + ga * _A_ref(h, A_k_cache, A_v_cache, A_wq, A_wo)
    h = _layernorm(x, axis=-1) * (1 + cb) + sb
    x = x + gb * _B_ref(h, B_w_gate, B_w_up, B_w_down)
    return x
```

```asm
; @launch grid=(256,1,1) block=(512,1,1) lds=155648
.amdgcn_target "amdgcn-amd-amdhsa--gfx950"
.text
.globl adaLN_cond__sliding_block_cached__glu_gated_bilinear__decode_kernel
.p2align 8
.type adaLN_cond__sliding_block_cached__glu_gated_bilinear__decode_kernel,@function
adaLN_cond__sliding_block_cached__glu_gated_bilinear__decode_kernel:
    s_cmp_ge_u32 s2, 256
    s_cbranch_scc1 L_end
    s_load_dwordx16 s[8:23], s[0:1], 0
    s_load_dwordx8 s[24:31], s[0:1], 64
    s_load_dwordx4 s[32:35], s[0:1], 96
    s_lshr_b32 s37, s2, 3
    s_and_b32 s36, s2, 7
    v_lshrrev_b32 v1, 6, v0
    s_cmp_ge_u32 s37, 16
    s_cbranch_scc1 L_att
    s_cmp_ge_u32 s37, 8
    s_cbranch_scc1 L_ga
    s_branch L_gc
L_att:
    v_readfirstlane_b32 s38, v1
    v_mov_b32 v60, 138752
    v_mov_b32 v56, 0
    v_mov_b32 v57, 0
    v_mov_b32 v58, 0
    v_mov_b32 v59, 0
    ds_write_b128 v60, v[56:59] offset:0
    ds_write_b128 v60, v[56:59] offset:16
    v_and_b32 v0, 63, v0
    v_and_b32 v1, 15, v0
    v_lshrrev_b32 v2, 4, v0
    s_sub_u32 s40, s37, 16
    s_and_b32 s43, s38, 3
    s_lshl_b32 s68, s36, 23
    s_lshl_b32 s41, s40, 16
    s_add_u32 s68, s68, s41
    s_lshl_b32 s70, s43, 14
    s_add_u32 s68, s68, s70
    s_add_u32 s68, s68, 0x700000
    v_xor_b32 v32, v1, v2
    v_lshlrev_b32 v32, 4, v32
    v_lshl_add_u32 v32, v2, 8, v32
    v_xor_b32 v33, 64, v32
    v_xor_b32 v34, 128, v32
    v_xor_b32 v35, 192, v32
    v_lshrrev_b32 v10, 1, v1
    v_and_b32 v11, 1, v0
    v_xor_b32 v12, v10, v2
    v_lshl_or_b32 v12, v12, 1, v11
    v_lshlrev_b32 v12, 4, v12
    v_lshl_add_u32 v12, v2, 8, v12
    v_xor_b32 v13, 128, v12
    s_waitcnt lgkmcnt(0)
    s_load_dword s39, s[34:35], 0
    s_cmp_ge_u32 s38, 4
    s_cbranch_scc1 L_att_V
    s_mov_b32 s44, s10
    s_and_b32 s45, s11, 0xffff
    s_mov_b32 s46, 67108864
    s_mov_b32 s47, 0x20000
    s_and_b32 s72, s36, 3
    s_xor_b32 s41, s72, 0
    s_lshl_b32 s41, s41, 12
    s_add_u32 s73, s68, s41
    s_add_u32 s41, s41, s70
    s_add_u32 m0, s41, 0
    s_nop 0
    buffer_load_dwordx4 v32, s[44:47], s73 offen nt lds
    buffer_load_dwordx4 v33, s[44:47], s73 offen offset:1024 nt lds
    buffer_load_dwordx4 v34, s[44:47], s73 offen offset:2048 nt lds
    buffer_load_dwordx4 v35, s[44:47], s73 offen offset:3072 nt lds
    s_xor_b32 s41, s72, 1
    s_lshl_b32 s41, s41, 12
    s_add_u32 s73, s68, s41
    s_add_u32 s41, s41, s70
    s_add_u32 m0, s41, 0
    s_nop 0
    buffer_load_dwordx4 v32, s[44:47], s73 offen nt lds
    buffer_load_dwordx4 v33, s[44:47], s73 offen offset:1024 nt lds
    buffer_load_dwordx4 v34, s[44:47], s73 offen offset:2048 nt lds
    buffer_load_dwordx4 v35, s[44:47], s73 offen offset:3072 nt lds
    s_xor_b32 s41, s72, 2
    s_lshl_b32 s41, s41, 12
    s_add_u32 s73, s68, s41
    s_add_u32 s41, s41, s70
    s_add_u32 m0, s41, 0
    s_nop 0
    buffer_load_dwordx4 v32, s[44:47], s73 offen nt lds
    buffer_load_dwordx4 v33, s[44:47], s73 offen offset:1024 nt lds
    buffer_load_dwordx4 v34, s[44:47], s73 offen offset:2048 nt lds
    buffer_load_dwordx4 v35, s[44:47], s73 offen offset:3072 nt lds
    s_xor_b32 s41, s72, 3
    s_lshl_b32 s41, s41, 12
    s_add_u32 s73, s68, s41
    s_add_u32 s41, s41, s70
    s_add_u32 m0, s41, 0
    s_nop 0
    buffer_load_dwordx4 v32, s[44:47], s73 offen nt lds
    buffer_load_dwordx4 v33, s[44:47], s73 offen offset:1024 nt lds
    buffer_load_dwordx4 v34, s[44:47], s73 offen offset:2048 nt lds
    buffer_load_dwordx4 v35, s[44:47], s73 offen offset:3072 nt lds
    s_barrier
    s_mov_b32 s60, s34
    s_and_b32 s61, s35, 0xffff
    s_mov_b32 s62, 2097152
    s_mov_b32 s63, 0x20000
    s_waitcnt lgkmcnt(0)
    s_add_u32 s39, s39, 0x01010101
    s_mov_b32 s76, s39
    s_lshr_b32 s77, s39, 8
    s_lshr_b32 s78, s39, 16
    s_lshr_b32 s79, s39, 24
    v_xor_b32 v112, v1, v2
    v_lshlrev_b32 v112, 4, v112
    v_lshl_add_u32 v112, v1, 8, v112
    v_add_u32 v112, s70, v112
    v_xor_b32 v113, 64, v112
    v_xor_b32 v114, 128, v112
    v_xor_b32 v115, 192, v112
    v_and_b32 v8, 3, v1
    v_lshlrev_b32 v8, 8, v8
    v_lshl_add_u32 v8, v2, 4, v8
    v_add_u32 v8, 131072, v8
    v_and_b32 v12, 3, v1
    v_mul_u32_u24 v12, 1088, v12
    v_lshl_add_u32 v12, v2, 4, v12
    s_lshl_b32 s41, s38, 8
    s_add_u32 s41, s41, 132096
    v_add_u32 v12, s41, v12
    s_mul_i32 s41, s38, 1088
    s_add_u32 s41, s41, 132096
    v_lshl_add_u32 v13, v0, 4, s41
    v_lshrrev_b32 v14, 3, v0
    v_lshlrev_b32 v14, 6, v14
    v_and_b32 v15, 3, v0
    v_lshl_add_u32 v14, v15, 4, v14
    v_bfe_u32 v15, v0, 2, 1
    v_lshl_add_u32 v14, v15, 3, v14
    s_mul_i32 s41, s38, 576
    s_add_u32 s41, s41, 136448
    v_add_u32 v14, s41, v14
    s_lshl_b32 s41, s36, 4
    s_add_u32 s41, s41, s40
    s_lshl_b32 s41, s41, 6
    s_lshl_b32 s42, s38, 4
    s_add_u32 s41, s41, s42
    s_add_u32 s41, s41, 327680
    v_mov_b32 v17, s41
    v_mov_b32 v18, 0xff
    s_mov_b32 s72, 0x3db504f3
    s_mov_b32 s73, 0x3db504f3
    s_mov_b32 s74, 0x3fb8aa3b
    s_mov_b32 s75, 0x3fb8aa3b
    s_lshl_b32 s41, s36, 12
    s_lshl_b32 s42, s38, 10
    s_add_u32 s41, s41, s42
    s_add_u32 s41, s41, 1507328
    v_lshl_add_u32 v20, v0, 4, s41
    v_add_u32 v22, 32768, v20
    v_add_u32 v10, 65536, v20
    v_add_u32 v11, 98304, v20
    s_lshl_b32 s42, s38, 8
    s_add_u32 s42, s42, 131072
    v_lshl_add_u32 v21, v0, 2, s42
    s_waitcnt vmcnt(0)
    ds_read_b128 v[32:35], v112 offset:0
    ds_read_b128 v[36:39], v113 offset:0
    ds_read_b128 v[40:43], v114 offset:0
    ds_read_b128 v[44:47], v115 offset:0
    ds_read_b128 v[48:51], v112 offset:4096
    ds_read_b128 v[52:55], v113 offset:4096
    ds_read_b128 v[56:59], v114 offset:4096
    ds_read_b128 v[60:63], v115 offset:4096
    ds_read_b128 v[64:67], v112 offset:8192
    ds_read_b128 v[68:71], v113 offset:8192
    ds_read_b128 v[72:75], v114 offset:8192
    ds_read_b128 v[76:79], v115 offset:8192
    ds_read_b128 v[80:83], v112 offset:12288
    ds_read_b128 v[84:87], v113 offset:12288
    ds_read_b128 v[88:91], v114 offset:12288
    ds_read_b128 v[92:95], v115 offset:12288
    s_mov_b32 s42, 131072
    s_mov_b32 s7, 0
L_poll_1:
    s_and_b32 s41, s7, 7
    s_cmp_eq_u32 s41, 7
    s_cselect_b32 s41, 0, s42
    buffer_load_dwordx4 v[24:27], v20, s[60:63], s41 offen sc1
    buffer_load_dwordx4 v[28:31], v22, s[60:63], s41 offen sc1
    buffer_load_dwordx4 v[116:119], v10, s[60:63], s41 offen sc1
    buffer_load_dwordx4 v[120:123], v11, s[60:63], s41 offen sc1
    s_waitcnt vmcnt(0)
    v_xor_b32 v25, s39, v25
    v_xor_b32 v27, s39, v27
    v_xor_b32 v29, s39, v29
    v_xor_b32 v31, s39, v31
    v_or3_b32 v25, v25, v27, v29
    v_xor_b32 v117, s39, v117
    v_xor_b32 v119, s39, v119
    v_xor_b32 v121, s39, v121
    v_xor_b32 v123, s39, v123
    v_or3_b32 v25, v25, v31, v117
    v_or3_b32 v25, v25, v119, v121
    v_or_b32 v25, v25, v123
    v_cmp_ne_u32 vcc, 0, v25
    s_cbranch_vccz L_ok_2
    s_add_u32 s7, s7, 1
    s_cmp_lt_u32 s7, 200000
    s_cbranch_scc1 L_poll_1
    s_branch L_end
L_ok_2:
    v_add_f32 v24, v24, v28
    v_add_f32 v26, v26, v30
    v_add_f32 v116, v116, v120
    v_add_f32 v118, v118, v122
    v_add_f32 v24, v24, v116
    v_add_f32 v26, v26, v118
    v_cvt_pk_bf16_f32 v24, v24, v26
    s_lshl_b32 s41, s38, 2
    s_add_u32 s41, s41, 138752
    v_mov_b32 v28, s41
    v_mov_b32 v29, s39
    ds_write_b32 v21, v24
    ds_write_b32 v28, v29
    v_mov_b32 v28, 138752
    s_mov_b32 s7, 0
L_poll_3:
    ds_read_b128 v[24:27], v28
    s_waitcnt lgkmcnt(0)
    v_xor_b32 v24, s39, v24
    v_xor_b32 v25, s39, v25
    v_xor_b32 v26, s39, v26
    v_xor_b32 v27, s39, v27
    v_or3_b32 v24, v24, v25, v26
    v_or_b32 v24, v24, v27
    v_cmp_ne_u32 vcc, 0, v24
    s_cbranch_vccz L_ok_4
    s_add_u32 s7, s7, 1
    s_cmp_lt_u32 s7, 200000
    s_cbranch_scc1 L_poll_3
    s_branch L_end
L_ok_4:
    ds_read_b128 v[96:99], v8 offset:0
    ds_read_b128 v[100:103], v8 offset:64
    ds_read_b128 v[104:107], v8 offset:128
    ds_read_b128 v[108:111], v8 offset:192
    s_waitcnt lgkmcnt(3)
    v_mfma_f32_16x16x32_bf16 v[24:27], v[32:35], v[96:99], 0
    v_mfma_f32_16x16x32_bf16 v[28:31], v[48:51], v[96:99], 0
    v_mfma_f32_16x16x32_bf16 v[116:119], v[64:67], v[96:99], 0
    v_mfma_f32_16x16x32_bf16 v[120:123], v[80:83], v[96:99], 0
    s_waitcnt lgkmcnt(2)
    v_mfma_f32_16x16x32_bf16 v[24:27], v[36:39], v[100:103], v[24:27]
    v_mfma_f32_16x16x32_bf16 v[28:31], v[52:55], v[100:103], v[28:31]
    v_mfma_f32_16x16x32_bf16 v[116:119], v[68:71], v[100:103], v[116:119]
    v_mfma_f32_16x16x32_bf16 v[120:123], v[84:87], v[100:103], v[120:123]
    s_waitcnt lgkmcnt(1)
    v_mfma_f32_16x16x32_bf16 v[24:27], v[40:43], v[104:107], v[24:27]
    v_mfma_f32_16x16x32_bf16 v[28:31], v[56:59], v[104:107], v[28:31]
    v_mfma_f32_16x16x32_bf16 v[116:119], v[72:75], v[104:107], v[116:119]
    v_mfma_f32_16x16x32_bf16 v[120:123], v[88:91], v[104:107], v[120:123]
    s_waitcnt lgkmcnt(0)
    v_mfma_f32_16x16x32_bf16 v[24:27], v[44:47], v[108:111], v[24:27]
    v_mfma_f32_16x16x32_bf16 v[28:31], v[60:63], v[108:111], v[28:31]
    v_mfma_f32_16x16x32_bf16 v[116:119], v[76:79], v[108:111], v[116:119]
    v_mfma_f32_16x16x32_bf16 v[120:123], v[92:95], v[108:111], v[120:123]
    s_mov_b32 exec_lo, 0x000f000f
    s_mov_b32 exec_hi, 0x000f000f
    s_nop 3
    ds_write_b128 v12, v[24:27] offset:0
    ds_write_b128 v12, v[28:31] offset:64
    ds_write_b128 v12, v[116:119] offset:128
    s_nop 3
    ds_write_b128 v12, v[120:123] offset:192
    s_mov_b64 exec, -1
    s_waitcnt lgkmcnt(0)
    s_barrier
    ds_read_b128 v[24:27], v13
    s_waitcnt lgkmcnt(0)
    v_cvt_pk_bf16_f32 v28, v24, v25
    v_cvt_pk_bf16_f32 v29, v26, v27
    v_lshlrev_b32 v24, 16, v28
    v_and_b32 v25, 0xffff0000, v28
    v_lshlrev_b32 v26, 16, v29
    v_and_b32 v27, 0xffff0000, v29
    v_pk_mul_f32 v[24:25], v[24:25], s[72:73]
    v_pk_mul_f32 v[26:27], v[26:27], s[72:73]
    v_cvt_pk_bf16_f32 v28, v24, v25
    v_cvt_pk_bf16_f32 v29, v26, v27
    v_lshlrev_b32 v24, 16, v28
    v_and_b32 v25, 0xffff0000, v28
    v_lshlrev_b32 v26, 16, v29
    v_and_b32 v27, 0xffff0000, v29
    v_max3_f32 v36, v24, v25, v26
    v_max_f32 v36, v36, v27
    s_nop 1
    v_max_f32_dpp v36, v36, v36 row_ror:8 row_mask:0xf bank_mask:0xf
    s_nop 1
    v_max_f32_dpp v36, v36, v36 row_ror:4 row_mask:0xf bank_mask:0xf
    s_nop 1
    v_max_f32_dpp v36, v36, v36 row_ror:2 row_mask:0xf bank_mask:0xf
    s_nop 1
    v_max_f32_dpp v36, v36, v36 row_ror:1 row_mask:0xf bank_mask:0xf
    s_nop 1
    v_mov_b32 v37, v36
    s_nop 1
    v_permlane16_swap_b32 v36, v37
    v_max_f32 v36, v36, v37
    v_mov_b32 v37, v36
    s_nop 1
    v_permlane32_swap_b32 v36, v37
    v_max_f32 v36, v36, v37
    v_mul_f32 v30, 0xbfb8aa3b, v36
    v_pk_fma_f32 v[24:25], v[24:25], s[74:75], v[30:31] op_sel_hi:[1,1,0]
    v_pk_fma_f32 v[26:27], v[26:27], s[74:75], v[30:31] op_sel_hi:[1,1,0]
    v_exp_f32 v24, v24
    v_exp_f32 v25, v25
    v_exp_f32 v26, v26
    v_exp_f32 v27, v27
    s_nop 0
    v_cvt_pk_bf16_f32 v28, v24, v25
    v_cvt_pk_bf16_f32 v29, v26, v27
    ds_write_b64 v14, v[28:29]
    v_pk_add_f32 v[24:25], v[24:25], v[26:27]
    v_add_f32 v37, v24, v25
    s_waitcnt lgkmcnt(0)
    s_barrier
    v_add_f32_dpp v37, v37, v37 row_ror:8 row_mask:0xf bank_mask:0xf
    s_nop 1
    v_add_f32_dpp v37, v37, v37 row_ror:4 row_mask:0xf bank_mask:0xf
    s_nop 1
    v_add_f32_dpp v37, v37, v37 row_ror:2 row_mask:0xf bank_mask:0xf
    s_nop 1
    v_add_f32_dpp v37, v37, v37 row_ror:1 row_mask:0xf bank_mask:0xf
    s_nop 1
    v_mov_b32 v38, v37
    s_nop 1
    v_permlane16_swap_b32 v37, v38
    v_add_f32 v37, v37, v38
    v_mov_b32 v38, v37
    s_nop 1
    v_permlane32_swap_b32 v37, v38
    v_add_f32 v37, v37, v38
    v_mov_b32 v38, 0
    v_mov_b32 v39, 0
    v_bfi_b32 v36, v18, s76, v36
    v_bfi_b32 v37, v18, s77, v37
    v_bfi_b32 v38, v18, s78, v38
    v_bfi_b32 v39, v18, s79, v39
    s_mov_b64 exec, 1
    s_mov_b32 s41, 524288
    buffer_store_dwordx4 v[36:39], v17, s[60:63], s41 offen
    buffer_store_dwordx4 v[36:39], v17, s[60:63], 0 offen sc1
    s_mov_b64 exec, -1
    s_branch L_att_done
L_att_V:
    s_mov_b32 s48, s12
    s_and_b32 s49, s13, 0xffff
    s_mov_b32 s50, 67108864
    s_mov_b32 s51, 0x20000
    s_lshr_b32 s72, s36, 1
    s_add_u32 s72, s72, s36
    s_add_u32 s72, s72, 2
    s_and_b32 s72, s72, 3
    s_xor_b32 s41, s72, 0
    s_lshl_b32 s41, s41, 12
    s_add_u32 s73, s68, s41
    s_add_u32 s41, s41, s70
    s_add_u32 m0, s41, 65536
    s_nop 0
    buffer_load_dwordx4 v12, s[48:51], s73 offen nt lds
    buffer_load_dwordx4 v13, s[48:51], s73 offen offset:1024 nt lds
    buffer_load_dwordx4 v12, s[48:51], s73 offen offset:2048 nt lds
    buffer_load_dwordx4 v13, s[48:51], s73 offen offset:3072 nt lds
    s_xor_b32 s41, s72, 1
    s_lshl_b32 s41, s41, 12
    s_add_u32 s73, s68, s41
    s_add_u32 s41, s41, s70
    s_add_u32 m0, s41, 65536
    s_nop 0
    buffer_load_dwordx4 v12, s[48:51], s73 offen nt lds
    buffer_load_dwordx4 v13, s[48:51], s73 offen offset:1024 nt lds
    buffer_load_dwordx4 v12, s[48:51], s73 offen offset:2048 nt lds
    buffer_load_dwordx4 v13, s[48:51], s73 offen offset:3072 nt lds
    s_xor_b32 s41, s72, 2
    s_lshl_b32 s41, s41, 12
    s_add_u32 s73, s68, s41
    s_add_u32 s41, s41, s70
    s_add_u32 m0, s41, 65536
    s_nop 0
    buffer_load_dwordx4 v12, s[48:51], s73 offen nt lds
    buffer_load_dwordx4 v13, s[48:51], s73 offen offset:1024 nt lds
    buffer_load_dwordx4 v12, s[48:51], s73 offen offset:2048 nt lds
    buffer_load_dwordx4 v13, s[48:51], s73 offen offset:3072 nt lds
    s_xor_b32 s41, s72, 3
    s_lshl_b32 s41, s41, 12
    s_add_u32 s73, s68, s41
    s_add_u32 s41, s41, s70
    s_add_u32 m0, s41, 65536
    s_nop 0
    buffer_load_dwordx4 v12, s[48:51], s73 offen nt lds
    buffer_load_dwordx4 v13, s[48:51], s73 offen offset:1024 nt lds
    buffer_load_dwordx4 v12, s[48:51], s73 offen offset:2048 nt lds
    buffer_load_dwordx4 v13, s[48:51], s73 offen offset:3072 nt lds
    s_barrier
    s_mov_b32 s60, s34
    s_and_b32 s61, s35, 0xffff
    s_mov_b32 s62, 2097152
    s_mov_b32 s63, 0x20000
    s_waitcnt lgkmcnt(0)
    s_add_u32 s39, s39, 0x01010101
    s_lshl_b32 s41, s43, 1
    v_lshrrev_b32 v10, 2, v0
    v_and_b32 v11, 7, v10
    v_xor_b32 v11, s41, v11
    v_lshlrev_b32 v11, 5, v11
    v_lshl_add_u32 v9, v10, 8, v11
    v_and_b32 v11, 3, v0
    v_lshl_add_u32 v9, v11, 3, v9
    v_add_u32 v9, 65536, v9
    v_xor_b32 v8, 32, v9
    v_lshrrev_b32 v15, 2, v1
    v_mul_u32_u24 v15, 576, v15
    v_lshl_add_u32 v15, v2, 4, v15
    v_add_u32 v15, 136448, v15
    s_lshl_b32 s41, s36, 4
    s_add_u32 s41, s41, s40
    s_lshl_b32 s42, s41, 11
    s_lshl_b32 s41, s43, 7
    s_add_u32 s42, s42, s41
    s_add_u32 s42, s42, 65536
    v_lshl_add_u32 v16, v2, 9, s42
    v_lshl_add_u32 v16, v1, 2, v16
    v_and_b32 v20, 3, v0
    v_lshlrev_b32 v20, 3, v20
    v_lshrrev_b32 v19, v20, s39
    v_mov_b32 v18, 0xff
    s_mov_b32 s74, 524288
    s_lshl_b32 s41, s43, 2
    s_add_u32 s41, s41, 138768
    v_mov_b32 v22, s41
    v_mov_b32 v23, s39
    v_mov_b32 v24, 138768
    s_waitcnt vmcnt(0)
    ds_write_b32 v22, v23
    s_mov_b32 s7, 0
L_poll_5:
    ds_read_b128 v[28:31], v24
    s_waitcnt lgkmcnt(0)
    v_xor_b32 v28, s39, v28
    v_xor_b32 v29, s39, v29
    v_xor_b32 v30, s39, v30
    v_xor_b32 v31, s39, v31
    v_or3_b32 v28, v28, v29, v30
    v_or_b32 v28, v28, v31
    v_cmp_ne_u32 vcc, 0, v28
    s_cbranch_vccz L_ok_6
    s_add_u32 s7, s7, 1
    s_cmp_lt_u32 s7, 200000
    s_cbranch_scc1 L_poll_5
    s_branch L_end
L_ok_6:
    ds_read_b64_tr_b16 v[48:49], v9 offset:0
    ds_read_b64_tr_b16 v[50:51], v9 offset:4096
    ds_read_b64_tr_b16 v[80:81], v8 offset:0
    ds_read_b64_tr_b16 v[82:83], v8 offset:4096
    ds_read_b64_tr_b16 v[52:53], v9 offset:8192
    ds_read_b64_tr_b16 v[54:55], v9 offset:12288
    s_waitcnt lgkmcnt(5)
    ds_read_b64_tr_b16 v[84:85], v8 offset:8192
    s_waitcnt lgkmcnt(5)
    ds_read_b64_tr_b16 v[86:87], v8 offset:12288
    s_waitcnt lgkmcnt(5)
    ds_read_b64_tr_b16 v[56:57], v9 offset:16384
    s_waitcnt lgkmcnt(5)
    ds_read_b64_tr_b16 v[58:59], v9 offset:20480
    s_waitcnt lgkmcnt(5)
    ds_read_b64_tr_b16 v[88:89], v8 offset:16384
    s_waitcnt lgkmcnt(5)
    ds_read_b64_tr_b16 v[90:91], v8 offset:20480
    s_waitcnt lgkmcnt(5)
    ds_read_b64_tr_b16 v[60:61], v9 offset:24576
    s_waitcnt lgkmcnt(5)
    ds_read_b64_tr_b16 v[62:63], v9 offset:28672
    s_waitcnt lgkmcnt(5)
    ds_read_b64_tr_b16 v[92:93], v8 offset:24576
    s_waitcnt lgkmcnt(5)
    ds_read_b64_tr_b16 v[94:95], v8 offset:28672
    s_waitcnt lgkmcnt(5)
    ds_read_b64_tr_b16 v[64:65], v9 offset:32768
    s_waitcnt lgkmcnt(5)
    ds_read_b64_tr_b16 v[66:67], v9 offset:36864
    s_waitcnt lgkmcnt(5)
    ds_read_b64_tr_b16 v[96:97], v8 offset:32768
    s_waitcnt lgkmcnt(5)
    ds_read_b64_tr_b16 v[98:99], v8 offset:36864
    s_barrier
    s_waitcnt lgkmcnt(5)
    ds_read_b64_tr_b16 v[68:69], v9 offset:40960
    s_waitcnt lgkmcnt(5)
    ds_read_b64_tr_b16 v[70:71], v9 offset:45056
    s_waitcnt lgkmcnt(5)
    ds_read_b64_tr_b16 v[100:101], v8 offset:40960
    s_waitcnt lgkmcnt(5)
    ds_read_b64_tr_b16 v[102:103], v8 offset:45056
    s_waitcnt lgkmcnt(5)
    ds_read_b64_tr_b16 v[72:73], v9 offset:49152
    s_waitcnt lgkmcnt(5)
    ds_read_b64_tr_b16 v[74:75], v9 offset:53248
    s_waitcnt lgkmcnt(5)
    ds_read_b64_tr_b16 v[104:105], v8 offset:49152
    s_waitcnt lgkmcnt(5)
    ds_read_b64_tr_b16 v[106:107], v8 offset:53248
    s_waitcnt lgkmcnt(5)
    ds_read_b64_tr_b16 v[76:77], v9 offset:57344
    s_waitcnt lgkmcnt(5)
    ds_read_b64_tr_b16 v[78:79], v9 offset:61440
    s_waitcnt lgkmcnt(5)
    ds_read_b64_tr_b16 v[108:109], v8 offset:57344
    s_waitcnt lgkmcnt(5)
    ds_read_b64_tr_b16 v[110:111], v8 offset:61440
    s_waitcnt lgkmcnt(0)
    s_barrier
    ds_read_b128 v[20:23], v15 offset:0
    ds_read_b128 v[24:27], v15 offset:64
    ds_read_b128 v[28:31], v15 offset:128
    ds_read_b128 v[32:35], v15 offset:192
    ds_read_b128 v[36:39], v15 offset:256
    ds_read_b128 v[40:43], v15 offset:320
    ds_read_b128 v[44:47], v15 offset:384
    ds_read_b128 v[112:115], v15 offset:448
    s_waitcnt lgkmcnt(7)
    v_mfma_f32_16x16x32_bf16 v[116:119], v[20:23], v[48:51], 0
    v_mfma_f32_16x16x32_bf16 v[120:123], v[20:23], v[80:83], 0
    s_waitcnt lgkmcnt(6)
    v_mfma_f32_16x16x32_bf16 v[116:119], v[24:27], v[52:55], v[116:119]
    v_mfma_f32_16x16x32_bf16 v[120:123], v[24:27], v[84:87], v[120:123]
    s_waitcnt lgkmcnt(5)
    v_mfma_f32_16x16x32_bf16 v[116:119], v[28:31], v[56:59], v[116:119]
    v_mfma_f32_16x16x32_bf16 v[120:123], v[28:31], v[88:91], v[120:123]
    s_waitcnt lgkmcnt(4)
    v_mfma_f32_16x16x32_bf16 v[116:119], v[32:35], v[60:63], v[116:119]
    v_mfma_f32_16x16x32_bf16 v[120:123], v[32:35], v[92:95], v[120:123]
    s_waitcnt lgkmcnt(3)
    v_mfma_f32_16x16x32_bf16 v[116:119], v[36:39], v[64:67], v[116:119]
    v_mfma_f32_16x16x32_bf16 v[120:123], v[36:39], v[96:99], v[120:123]
    s_waitcnt lgkmcnt(2)
    v_mfma_f32_16x16x32_bf16 v[116:119], v[40:43], v[68:71], v[116:119]
    v_mfma_f32_16x16x32_bf16 v[120:123], v[40:43], v[100:103], v[120:123]
    s_waitcnt lgkmcnt(1)
    v_mfma_f32_16x16x32_bf16 v[116:119], v[44:47], v[72:75], v[116:119]
    v_mfma_f32_16x16x32_bf16 v[120:123], v[44:47], v[104:107], v[120:123]
    s_waitcnt lgkmcnt(0)
    v_mfma_f32_16x16x32_bf16 v[116:119], v[112:115], v[76:79], v[116:119]
    v_mfma_f32_16x16x32_bf16 v[120:123], v[112:115], v[108:111], v[120:123]
    s_nop 6
    v_bfi_b32 v116, v18, v19, v116
    buffer_store_dword v116, v16, s[60:63], s74 offen
    v_bfi_b32 v120, v18, v19, v120
    buffer_store_dword v120, v16, s[60:63], s74 offen offset:64
    buffer_store_dword v116, v16, s[60:63], 0 offen sc1
    buffer_store_dword v120, v16, s[60:63], 0 offen offset:64 sc1
L_att_done:
    s_mov_b64 exec, -1
    s_endpgm
L_ga:
    v_readfirstlane_b32 s38, v1
    v_mov_b32 v60, 133120
    v_mov_b32 v56, 0
    v_mov_b32 v57, 0
    v_mov_b32 v58, 0
    v_mov_b32 v59, 0
    ds_write_b128 v60, v[56:59] offset:0
    ds_write_b128 v60, v[56:59] offset:16
    ds_write_b128 v60, v[56:59] offset:32
    ds_write_b128 v60, v[56:59] offset:48
    ds_write_b128 v60, v[56:59] offset:64
    v_and_b32 v0, 63, v0
    v_and_b32 v1, 15, v0
    v_lshrrev_b32 v2, 4, v0
    s_sub_u32 s43, s37, 8
    s_lshl_b32 s40, s36, 3
    s_add_u32 s40, s40, s43
    s_mul_i32 s6, s36, 7
    s_add_u32 s6, s6, s43
    s_sub_u32 s71, s38, 4
    s_lshr_b32 s72, s43, 1
    s_and_b32 s73, s43, 1
    v_and_b32 v8, 31, v0
    v_lshrrev_b32 v9, 5, v0
    v_lshrrev_b32 v7, 1, v8
    v_xor_b32 v7, v7, v9
    v_and_b32 v8, 1, v8
    v_lshl_or_b32 v7, v7, 1, v8
    v_lshlrev_b32 v7, 4, v7
    v_lshl_add_u32 v32, v9, 13, v7
    v_xor_b32 v33, 64, v32
    v_xor_b32 v34, 128, v32
    v_xor_b32 v35, 192, v32
    s_lshl_b32 s41, s72, 2
    s_add_u32 s41, s41, s71
    s_lshl_b32 s68, s41, 18
    s_lshl_b32 s41, s36, 10
    s_add_u32 s68, s68, s41
    s_lshl_b32 s41, s73, 9
    s_add_u32 s68, s68, s41
    s_lshl_b32 s70, s71, 14
    s_waitcnt lgkmcnt(0)
    s_load_dword s39, s[34:35], 0
    s_cmp_ge_u32 s38, 4
    s_cbranch_scc1 L_ga_L
    s_cmp_ge_u32 s38, 2
    s_cbranch_scc1 L_ga_W
    s_mov_b32 s64, s8
    s_and_b32 s65, s9, 0xffff
    s_mov_b32 s66, 1024
    s_mov_b32 s67, 0x20000
    s_lshr_b32 s71, s43, 1
    s_lshl_b32 s71, s71, 1
    s_add_u32 s71, s71, s38
    s_lshl_b32 s41, s71, 7
    v_and_b32 v3, 31, v0
    v_lshl_add_u32 v3, v3, 2, s41
    buffer_load_dword v8, v3, s[64:67], 0 offen
    v_lshlrev_b32 v5, 4, v0
    buffer_load_dwordx4 v[12:15], v5, s[64:67], 0 offen
    v_bfe_u32 v17, v0, 4, 1
    v_lshlrev_b32 v17, 6, v17
    v_bfe_u32 v18, v0, 1, 2
    v_lshl_add_u32 v17, v18, 4, v17
    v_bfe_u32 v18, v0, 3, 1
    v_lshl_add_u32 v17, v18, 3, v17
    v_and_b32 v18, 1, v0
    v_lshl_add_u32 v17, v18, 2, v17
    s_lshl_b32 s41, s38, 7
    s_add_u32 s41, s41, 131072
    v_add_u32 v17, s41, v17
    s_mov_b32 s60, s34
    s_and_b32 s61, s35, 0xffff
    s_mov_b32 s62, 2097152
    s_mov_b32 s63, 0x20000
    s_waitcnt lgkmcnt(0)
    s_add_u32 s39, s39, 0x01010101
    s_lshl_b32 s41, s71, 9
    s_add_u32 s41, s41, 1441792
    v_and_b32 v18, 31, v0
    v_lshl_add_u32 v18, v18, 4, s41
    v_lshrrev_b32 v16, 5, v0
    v_lshl_add_u32 v18, v16, 12, v18
    s_mov_b32 s72, 8192
    s_mov_b32 s73, 16384
    s_mov_b32 s74, 24576
    v_mov_b32 v24, 0
    v_mov_b32 v25, 0
    v_mov_b32 v26, 0
    v_mov_b32 v27, 0
    v_lshlrev_b32 v28, 4, v1
    v_add_u32 v28, 133632, v28
    ds_write_b128 v28, v[24:27]
    s_waitcnt vmcnt(0)
    v_lshlrev_b32 v44, 16, v12
    v_and_b32 v45, 0xffff0000, v12
    v_lshlrev_b32 v46, 16, v13
    v_and_b32 v47, 0xffff0000, v13
    v_lshlrev_b32 v48, 16, v14
    v_and_b32 v49, 0xffff0000, v14
    v_lshlrev_b32 v50, 16, v15
    v_and_b32 v51, 0xffff0000, v15
    v_pk_add_f32 v[52:53], v[44:45], v[46:47]
    v_pk_add_f32 v[54:55], v[48:49], v[50:51]
    v_pk_add_f32 v[52:53], v[52:53], v[54:55]
    v_add_f32 v52, v52, v53
    s_nop 1
    v_add_f32_dpp v52, v52, v52 row_ror:8 row_mask:0xf bank_mask:0xf
    s_nop 1
    v_add_f32_dpp v52, v52, v52 row_ror:4 row_mask:0xf bank_mask:0xf
    s_nop 1
    v_add_f32_dpp v52, v52, v52 row_ror:2 row_mask:0xf bank_mask:0xf
    s_nop 1
    v_add_f32_dpp v52, v52, v52 row_ror:1 row_mask:0xf bank_mask:0xf
    s_nop 1
    v_mov_b32 v53, v52
    s_nop 1
    v_permlane16_swap_b32 v52, v53
    v_add_f32 v52, v52, v53
    v_mov_b32 v53, v52
    s_nop 1
    v_permlane32_swap_b32 v52, v53
    v_add_f32 v52, v52, v53
    v_mul_f32 v52, 0x3b000000, v52
    v_sub_f32 v44, v44, v52
    v_sub_f32 v45, v45, v52
    v_sub_f32 v46, v46, v52
    v_sub_f32 v47, v47, v52
    v_sub_f32 v48, v48, v52
    v_sub_f32 v49, v49, v52
    v_sub_f32 v50, v50, v52
    v_sub_f32 v51, v51, v52
    v_mul_f32 v54, v44, v44
    v_fmac_f32 v54, v45, v45
    v_fmac_f32 v54, v46, v46
    v_fmac_f32 v54, v47, v47
    v_fmac_f32 v54, v48, v48
    v_fmac_f32 v54, v49, v49
    v_fmac_f32 v54, v50, v50
    v_fmac_f32 v54, v51, v51
    s_nop 1
    v_add_f32_dpp v54, v54, v54 row_ror:8 row_mask:0xf bank_mask:0xf
    s_nop 1
    v_add_f32_dpp v54, v54, v54 row_ror:4 row_mask:0xf bank_mask:0xf
    s_nop 1
    v_add_f32_dpp v54, v54, v54 row_ror:2 row_mask:0xf bank_mask:0xf
    s_nop 1
    v_add_f32_dpp v54, v54, v54 row_ror:1 row_mask:0xf bank_mask:0xf
    s_nop 1
    v_mov_b32 v53, v54
    s_nop 1
    v_permlane16_swap_b32 v54, v53
    v_add_f32 v54, v54, v53
    v_mov_b32 v53, v54
    s_nop 1
    v_permlane32_swap_b32 v54, v53
    v_add_f32 v54, v54, v53
    v_mul_f32 v54, 0x3b000000, v54
    v_cvt_pk_bf16_f32 v55, v52, v54
    v_lshlrev_b32 v52, 16, v55
    v_and_b32 v54, 0xffff0000, v55
    v_add_f32 v54, 0x3727c5ac, v54
    v_cvt_pk_bf16_f32 v55, v54, v54
    v_lshlrev_b32 v54, 16, v55
    v_sqrt_f32 v54, v54
    s_nop 0
    v_cvt_pk_bf16_f32 v55, v54, v54
    v_lshlrev_b32 v54, 16, v55
    v_rcp_f32 v53, v54
    s_nop 0
    v_lshlrev_b32 v12, 16, v8
    v_and_b32 v13, 0xffff0000, v8
    v_sub_f32 v12, v12, v52
    v_sub_f32 v13, v13, v52
    v_cvt_pk_bf16_f32 v55, v12, v13
    v_lshlrev_b32 v12, 16, v55
    v_and_b32 v13, 0xffff0000, v55
    v_mul_f32 v46, v12, v53
    v_mul_f32 v47, v13, v53
    v_fma_f32 v12, -v54, v46, v12
    v_fma_f32 v13, -v54, v47, v13
    v_fma_f32 v12, v12, v53, v46
    v_fma_f32 v13, v13, v53, v47
    v_cvt_pk_bf16_f32 v55, v12, v13
    v_lshlrev_b32 v12, 16, v55
    v_and_b32 v13, 0xffff0000, v55
    s_mov_b32 s76, s39
    s_lshr_b32 s77, s39, 8
    s_lshr_b32 s78, s39, 16
    s_lshr_b32 s79, s39, 24
    v_mov_b32 v158, 0x0c0c0400
    v_mov_b32 v159, 0x04000c0c
    v_mov_b32 v157, 0xff
    v_and_b32 v44, 3, v0
    v_lshlrev_b32 v44, 3, v44
    v_lshrrev_b32 v156, v44, s39
    s_lshl_b32 s41, s38, 8
    s_add_u32 s41, s41, 393216
    v_lshl_add_u32 v144, v1, 4, s41
    v_lshl_add_u32 v144, v2, 11, v144
    v_add_u32 v145, 8192, v144
    s_lshl_b32 s41, s38, 3
    s_add_u32 s41, s41, 132096
    v_mov_b32 v146, s41
    v_mov_b32 v147, 132096
    s_lshl_b32 s41, s38, 7
    s_add_u32 s41, s41, 131072
    v_lshrrev_b32 v148, 3, v1
    v_lshlrev_b32 v148, 6, v148
    v_and_b32 v44, 3, v1
    v_lshl_add_u32 v148, v44, 4, v148
    v_bfe_u32 v44, v1, 2, 1
    v_lshl_add_u32 v148, v44, 3, v148
    v_add_u32 v148, s41, v148
    v_lshlrev_b32 v149, 4, v2
    v_add_u32 v149, 131072, v149
    s_lshl_b32 s41, s38, 1
    v_add_u32 v150, s41, v2
    v_and_b32 v150, 3, v150
    v_lshlrev_b32 v150, 4, v150
    s_lshr_b32 s41, s38, 1
    s_and_b32 s41, s41, 1
    s_lshl_b32 s41, s41, 3
    s_add_u32 s41, s41, 132160
    v_add_u32 v150, s41, v150
    v_lshlrev_b32 v45, 4, v2
    v_add_u32 v45, 132160, v45
    v_mov_b32 v46, 132224
    v_lshrrev_b32 v44, 2, v1
    v_cmp_eq_u32 s[80:81], 0, v44
    s_nop 1
    v_cndmask_b32 v151, v46, v45, s[80:81]
    v_cmp_eq_u32 s[80:81], 1, v44
    s_nop 1
    v_cndmask_b32 v152, v46, v45, s[80:81]
    v_cmp_eq_u32 s[80:81], 2, v44
    s_nop 1
    v_cndmask_b32 v153, v46, v45, s[80:81]
    v_cmp_eq_u32 s[80:81], 3, v44
    s_nop 1
    v_cndmask_b32 v154, v46, v45, s[80:81]
    s_lshl_b32 s41, s6, 11
    s_lshl_b32 s42, s38, 8
    s_add_u32 s41, s41, s42
    s_add_u32 s41, s41, 458752
    v_lshl_add_u32 v155, v0, 2, s41
    v_mov_b32 v48, 0
    v_mov_b32 v49, 0
    v_mov_b32 v50, 0
    v_mov_b32 v51, 0
    ds_write_b128 v46, v[48:51]
    s_barrier
    v_mov_b32 v60, 133136
    s_mov_b32 s7, 0
L_poll_7:
    ds_read_b128 v[56:59], v60
    s_waitcnt lgkmcnt(0)
    v_xor_b32 v56, s39, v56
    v_xor_b32 v57, s39, v57
    v_xor_b32 v58, s39, v58
    v_xor_b32 v59, s39, v59
    v_or3_b32 v56, v56, v57, v58
    v_or_b32 v56, v56, v59
    v_cmp_ne_u32 vcc, 0, v56
    s_cbranch_vccz L_ok_8
    s_add_u32 s7, s7, 1
    s_cmp_lt_u32 s7, 200000
    s_cbranch_scc1 L_poll_7
    s_branch L_end
L_ok_8:
    buffer_load_dwordx4 v[24:27], v18, s[60:63], 0 offen sc1
    buffer_load_dwordx4 v[28:31], v18, s[60:63], s72 offen sc1
    buffer_load_dwordx4 v[32:35], v18, s[60:63], s73 offen sc1
    buffer_load_dwordx4 v[36:39], v18, s[60:63], s74 offen sc1
    v_mov_b32 v60, 133120
    s_mov_b32 s7, 0
L_poll_11:
    ds_read_b96 v[56:58], v60
    s_waitcnt lgkmcnt(0)
    v_xor_b32 v56, s39, v56
    v_xor_b32 v57, s39, v57
    v_xor_b32 v58, s39, v58
    v_or3_b32 v56, v56, v57, v58
    v_cmp_ne_u32 vcc, 0, v56
    s_cbranch_vccz L_ok_12
    s_add_u32 s7, s7, 1
    s_cmp_lt_u32 s7, 200000
    s_cbranch_scc1 L_poll_11
    s_branch L_end
L_ok_12:
    buffer_load_dwordx4 v[64:67], v18, s[60:63], 0 offen sc1
    buffer_load_dwordx4 v[68:71], v18, s[60:63], s72 offen sc1
    buffer_load_dwordx4 v[72:75], v18, s[60:63], s73 offen sc1
    buffer_load_dwordx4 v[76:79], v18, s[60:63], s74 offen sc1
    s_waitcnt vmcnt(4)
    v_xor_b32 v44, s39, v25
    v_xor_b32 v45, s39, v27
    v_xor_b32 v46, s39, v29
    v_xor_b32 v47, s39, v31
    v_xor_b32 v48, s39, v33
    v_xor_b32 v49, s39, v35
    v_xor_b32 v50, s39, v37
    v_xor_b32 v51, s39, v39
    v_or3_b32 v44, v44, v45, v46
    v_or3_b32 v47, v47, v48, v49
    v_or3_b32 v44, v44, v50, v51
    v_or_b32 v44, v44, v47
    v_cmp_ne_u32 vcc, 0, v44
    s_cbranch_vccz L_e1ok_9_drain
    s_waitcnt vmcnt(0)
    v_xor_b32 v44, s39, v65
    v_xor_b32 v45, s39, v67
    v_xor_b32 v46, s39, v69
    v_xor_b32 v47, s39, v71
    v_xor_b32 v48, s39, v73
    v_xor_b32 v49, s39, v75
    v_xor_b32 v50, s39, v77
    v_xor_b32 v51, s39, v79
    v_or3_b32 v44, v44, v45, v46
    v_or3_b32 v47, v47, v48, v49
    v_or3_b32 v44, v44, v50, v51
    v_or_b32 v44, v44, v47
    v_cmp_ne_u32 vcc, 0, v44
    s_cbranch_vccz L_e1b_10
    s_mov_b32 s7, 0
L_poll_13:
    buffer_load_dwordx4 v[24:27], v18, s[60:63], 0 offen sc1
    buffer_load_dwordx4 v[28:31], v18, s[60:63], s72 offen sc1
    buffer_load_dwordx4 v[32:35], v18, s[60:63], s73 offen sc1
    buffer_load_dwordx4 v[36:39], v18, s[60:63], s74 offen sc1
    s_waitcnt vmcnt(0)
    v_xor_b32 v44, s39, v25
    v_xor_b32 v45, s39, v27
    v_xor_b32 v46, s39, v29
    v_xor_b32 v47, s39, v31
    v_xor_b32 v48, s39, v33
    v_xor_b32 v49, s39, v35
    v_xor_b32 v50, s39, v37
    v_xor_b32 v51, s39, v39
    v_or3_b32 v44, v44, v45, v46
    v_or3_b32 v47, v47, v48, v49
    v_or3_b32 v44, v44, v50, v51
    v_or_b32 v44, v44, v47
    v_cmp_ne_u32 vcc, 0, v44
    s_cbranch_vccz L_ok_14
    s_add_u32 s7, s7, 1
    s_cmp_lt_u32 s7, 200000
    s_cbranch_scc1 L_poll_13
    s_branch L_end
L_ok_14:
    s_branch L_e1ok_9
L_e1b_10:
    v_mov_b32 v24, v64
    v_mov_b32 v26, v66
    v_mov_b32 v28, v68
    v_mov_b32 v30, v70
    v_mov_b32 v32, v72
    v_mov_b32 v34, v74
    v_mov_b32 v36, v76
    v_mov_b32 v38, v78
L_e1ok_9_drain:
L_e1ok_9:
    v_add_f32 v24, v24, v28
    v_add_f32 v26, v26, v30
    v_add_f32 v32, v32, v36
    v_add_f32 v34, v34, v38
    v_add_f32 v24, v24, v32
    v_add_f32 v26, v26, v34
    v_cvt_pk_bf16_f32 v24, v24, v26
    v_mov_b32 v25, v24
    s_nop 1
    v_permlane32_swap_b32 v24, v25
    v_lshlrev_b32 v28, 16, v25
    v_and_b32 v29, 0xffff0000, v25
    v_pk_add_f32 v[28:29], v[28:29], 1.0 op_sel_hi:[1,0]
    v_cvt_pk_bf16_f32 v44, v28, v29
    v_lshlrev_b32 v28, 16, v44
    v_and_b32 v29, 0xffff0000, v44
    v_pk_mul_f32 v[28:29], v[12:13], v[28:29]
    v_cvt_pk_bf16_f32 v44, v28, v29
    v_lshlrev_b32 v28, 16, v44
    v_and_b32 v29, 0xffff0000, v44
    v_lshlrev_b32 v32, 16, v24
    v_and_b32 v33, 0xffff0000, v24
    v_pk_add_f32 v[28:29], v[28:29], v[32:33]
    v_cvt_pk_bf16_f32 v28, v28, v29
    ds_write_b32 v17, v28
    s_lshl_b32 s41, s38, 2
    s_add_u32 s41, s41, 133168
    v_mov_b32 v44, s41
    v_mov_b32 v45, s39
    ds_write_b32 v44, v45
    s_branch L_f0
L_ga_W:
    s_and_b32 s71, s38, 1
    s_mov_b32 s44, s20
    s_and_b32 s45, s21, 0xffff
    s_mov_b32 s46, 1835008
    s_mov_b32 s47, 0x20000
    s_mov_b32 s48, s22
    s_and_b32 s49, s23, 0xffff
    s_mov_b32 s50, 1835008
    s_mov_b32 s51, 0x20000
    s_mov_b32 s52, s24
    s_and_b32 s53, s25, 0xffff
    s_mov_b32 s54, 1835008
    s_mov_b32 s55, 0x20000
    v_and_b32 v4, 3, v0
    v_and_b32 v5, 1, v2
    v_lshlrev_b32 v5, 1, v5
    v_xor_b32 v4, v4, v5
    v_lshlrev_b32 v4, 4, v4
    v_lshrrev_b32 v5, 2, v0
    v_mul_u32_u24 v5, 3584, v5
    v_add_u32 v4, v4, v5
    v_xor_b32 v5, 16, v4
    s_mul_i32 s68, s71, 917504
    s_lshl_b32 s41, s6, 6
    s_add_u32 s68, s68, s41
    s_mov_b32 s69, s68
    s_lshl_b32 s70, s71, 14
    v_bfe_u32 v8, v0, 1, 2
    v_and_b32 v9, 3, v2
    v_xor_b32 v8, v8, v9
    v_and_b32 v9, 1, v0
    v_lshl_or_b32 v8, v8, 1, v9
    v_lshlrev_b32 v8, 4, v8
    v_lshrrev_b32 v7, 3, v0
    v_lshl_add_u32 v7, v7, 10, v8
    s_mov_b32 s60, s34
    s_and_b32 s61, s35, 0xffff
    s_mov_b32 s62, 2097152
    s_mov_b32 s63, 0x20000
    s_waitcnt lgkmcnt(0)
    s_add_u32 s39, s39, 0x01010101
    s_mov_b32 s76, s39
    s_lshr_b32 s77, s39, 8
    s_lshr_b32 s78, s39, 16
    s_lshr_b32 s79, s39, 24
    v_mov_b32 v158, 0x0c0c0400
    v_mov_b32 v159, 0x04000c0c
    v_mov_b32 v157, 0xff
    v_and_b32 v44, 3, v0
    v_lshlrev_b32 v44, 3, v44
    v_lshrrev_b32 v156, v44, s39
    s_lshl_b32 s41, s38, 8
    s_add_u32 s41, s41, 393216
    v_lshl_add_u32 v144, v1, 4, s41
    v_lshl_add_u32 v144, v2, 11, v144
    v_add_u32 v145, 8192, v144
    s_lshl_b32 s41, s38, 3
    s_add_u32 s41, s41, 132096
    v_mov_b32 v146, s41
    v_mov_b32 v147, 132096
    s_lshl_b32 s41, s38, 7
    s_add_u32 s41, s41, 131072
    v_lshrrev_b32 v148, 3, v1
    v_lshlrev_b32 v148, 6, v148
    v_and_b32 v44, 3, v1
    v_lshl_add_u32 v148, v44, 4, v148
    v_bfe_u32 v44, v1, 2, 1
    v_lshl_add_u32 v148, v44, 3, v148
    v_add_u32 v148, s41, v148
    v_lshlrev_b32 v149, 4, v2
    v_add_u32 v149, 131072, v149
    s_lshl_b32 s41, s38, 1
    v_add_u32 v150, s41, v2
    v_and_b32 v150, 3, v150
    v_lshlrev_b32 v150, 4, v150
    s_lshr_b32 s41, s38, 1
    s_and_b32 s41, s41, 1
    s_lshl_b32 s41, s41, 3
    s_add_u32 s41, s41, 132160
    v_add_u32 v150, s41, v150
    v_lshlrev_b32 v45, 4, v2
    v_add_u32 v45, 132160, v45
    v_mov_b32 v46, 132224
    v_lshrrev_b32 v44, 2, v1
    v_cmp_eq_u32 s[80:81], 0, v44
    s_nop 1
    v_cndmask_b32 v151, v46, v45, s[80:81]
    v_cmp_eq_u32 s[80:81], 1, v44
    s_nop 1
    v_cndmask_b32 v152, v46, v45, s[80:81]
    v_cmp_eq_u32 s[80:81], 2, v44
    s_nop 1
    v_cndmask_b32 v153, v46, v45, s[80:81]
    v_cmp_eq_u32 s[80:81], 3, v44
    s_nop 1
    v_cndmask_b32 v154, v46, v45, s[80:81]
    s_lshl_b32 s41, s6, 11
    s_lshl_b32 s42, s38, 8
    s_add_u32 s41, s41, s42
    s_add_u32 s41, s41, 458752
    v_lshl_add_u32 v155, v0, 2, s41
    v_mov_b32 v48, 0
    v_mov_b32 v49, 0
    v_mov_b32 v50, 0
    v_mov_b32 v51, 0
    ds_write_b128 v46, v[48:51]
    s_barrier
    s_cmp_eq_u32 s43, 7
    s_cbranch_scc1 L_ga_done
    v_mov_b32 v24, 133184
    s_mov_b32 s7, 0
L_poll_15:
    ds_read_b128 v[28:31], v24
    s_waitcnt lgkmcnt(0)
    v_xor_b32 v28, s39, v28
    v_xor_b32 v29, s39, v29
    v_xor_b32 v30, s39, v30
    v_xor_b32 v31, s39, v31
    v_or3_b32 v28, v28, v29, v30
    v_or_b32 v28, v28, v31
    v_cmp_ne_u32 vcc, 0, v28
    s_cbranch_vccz L_ok_16
    s_add_u32 s7, s7, 1
    s_cmp_lt_u32 s7, 200000
    s_cbranch_scc1 L_poll_15
    s_branch L_end
L_ok_16:
    s_mov_b32 m0, s70
    s_nop 0
    buffer_load_dwordx4 v4, s[44:47], s68 offen nt lds
    s_add_u32 m0, s70, 1024
    s_add_u32 s68, s68, 57344
    buffer_load_dwordx4 v4, s[44:47], s68 offen nt lds
    s_add_u32 m0, s70, 2048
    s_add_u32 s68, s68, 57344
    buffer_load_dwordx4 v4, s[44:47], s68 offen nt lds
    s_add_u32 m0, s70, 3072
    s_add_u32 s68, s68, 57344
    buffer_load_dwordx4 v4, s[44:47], s68 offen nt lds
    s_add_u32 m0, s70, 4096
    s_add_u32 s68, s68, 57344
    buffer_load_dwordx4 v4, s[44:47], s68 offen nt lds
    s_add_u32 m0, s70, 5120
    s_add_u32 s68, s68, 57344
    buffer_load_dwordx4 v4, s[44:47], s68 offen nt lds
    s_add_u32 m0, s70, 6144
    s_add_u32 s68, s68, 57344
    buffer_load_dwordx4 v4, s[44:47], s68 offen nt lds
    s_add_u32 m0, s70, 7168
    s_add_u32 s68, s68, 57344
    buffer_load_dwordx4 v4, s[44:47], s68 offen nt lds
    s_add_u32 m0, s70, 8192
    s_add_u32 s68, s68, 57344
    buffer_load_dwordx4 v4, s[44:47], s68 offen nt lds
    s_add_u32 m0, s70, 9216
    s_add_u32 s68, s68, 57344
    buffer_load_dwordx4 v4, s[44:47], s68 offen nt lds
    s_add_u32 m0, s70, 10240
    s_add_u32 s68, s68, 57344
    buffer_load_dwordx4 v4, s[44:47], s68 offen nt lds
    s_add_u32 m0, s70, 11264
    s_add_u32 s68, s68, 57344
    buffer_load_dwordx4 v4, s[44:47], s68 offen nt lds
    s_add_u32 m0, s70, 12288
    s_add_u32 s68, s68, 57344
    buffer_load_dwordx4 v4, s[44:47], s68 offen nt lds
    s_add_u32 m0, s70, 13312
    s_add_u32 s68, s68, 57344
    buffer_load_dwordx4 v4, s[44:47], s68 offen nt lds
    s_add_u32 m0, s70, 14336
    s_add_u32 s68, s68, 57344
    buffer_load_dwordx4 v4, s[44:47], s68 offen nt lds
    s_add_u32 m0, s70, 15360
    s_add_u32 s68, s68, 57344
    buffer_load_dwordx4 v4, s[44:47], s68 offen nt lds
    s_add_u32 m0, s70, 32768
    s_nop 0
    buffer_load_dwordx4 v5, s[48:51], s69 offen nt lds
    s_add_u32 m0, s70, 33792
    s_add_u32 s69, s69, 57344
    buffer_load_dwordx4 v5, s[48:51], s69 offen nt lds
    s_add_u32 m0, s70, 34816
    s_add_u32 s69, s69, 57344
    buffer_load_dwordx4 v5, s[48:51], s69 offen nt lds
    s_add_u32 m0, s70, 35840
    s_add_u32 s69, s69, 57344
    buffer_load_dwordx4 v5, s[48:51], s69 offen nt lds
    s_add_u32 m0, s70, 36864
    s_add_u32 s69, s69, 57344
    buffer_load_dwordx4 v5, s[48:51], s69 offen nt lds
    s_add_u32 m0, s70, 37888
    s_add_u32 s69, s69, 57344
    buffer_load_dwordx4 v5, s[48:51], s69 offen nt lds
    s_add_u32 m0, s70, 38912
    s_add_u32 s69, s69, 57344
    buffer_load_dwordx4 v5, s[48:51], s69 offen nt lds
    s_add_u32 m0, s70, 39936
    s_add_u32 s69, s69, 57344
    buffer_load_dwordx4 v5, s[48:51], s69 offen nt lds
    s_add_u32 m0, s70, 40960
    s_add_u32 s69, s69, 57344
    buffer_load_dwordx4 v5, s[48:51], s69 offen nt lds
    s_add_u32 m0, s70, 41984
    s_add_u32 s69, s69, 57344
    buffer_load_dwordx4 v5, s[48:51], s69 offen nt lds
    s_add_u32 m0, s70, 43008
    s_add_u32 s69, s69, 57344
    buffer_load_dwordx4 v5, s[48:51], s69 offen nt lds
    s_add_u32 m0, s70, 44032
    s_add_u32 s69, s69, 57344
    buffer_load_dwordx4 v5, s[48:51], s69 offen nt lds
    s_add_u32 m0, s70, 45056
    s_add_u32 s69, s69, 57344
    buffer_load_dwordx4 v5, s[48:51], s69 offen nt lds
    s_add_u32 m0, s70, 46080
    s_add_u32 s69, s69, 57344
    buffer_load_dwordx4 v5, s[48:51], s69 offen nt lds
    s_add_u32 m0, s70, 47104
    s_add_u32 s69, s69, 57344
    buffer_load_dwordx4 v5, s[48:51], s69 offen nt lds
    s_add_u32 m0, s70, 48128
    s_add_u32 s69, s69, 57344
    buffer_load_dwordx4 v5, s[48:51], s69 offen nt lds
    s_lshl_b32 s68, s6, 15
    s_lshl_b32 s41, s71, 9
    s_add_u32 s68, s68, s41
    s_add_u32 s69, s68, 0
    s_add_u32 m0, s70, 65536
    s_nop 0
    buffer_load_dwordx4 v7, s[52:55], s69 offen nt lds
    s_add_u32 m0, s70, 66560
    s_add_u32 s69, s69, 8192
    buffer_load_dwordx4 v7, s[52:55], s69 offen nt lds
    s_add_u32 m0, s70, 67584
    s_add_u32 s69, s69, 8192
    buffer_load_dwordx4 v7, s[52:55], s69 offen nt lds
    s_add_u32 m0, s70, 68608
    s_add_u32 s69, s69, 8192
    buffer_load_dwordx4 v7, s[52:55], s69 offen nt lds
    s_add_u32 s69, s68, 128
    s_add_u32 m0, s70, 69632
    s_nop 0
    buffer_load_dwordx4 v7, s[52:55], s69 offen nt lds
    s_add_u32 m0, s70, 70656
    s_add_u32 s69, s69, 8192
    buffer_load_dwordx4 v7, s[52:55], s69 offen nt lds
    s_add_u32 m0, s70, 71680
    s_add_u32 s69, s69, 8192
    buffer_load_dwordx4 v7, s[52:55], s69 offen nt lds
    s_add_u32 m0, s70, 72704
    s_add_u32 s69, s69, 8192
    buffer_load_dwordx4 v7, s[52:55], s69 offen nt lds
    s_add_u32 s69, s68, 256
    s_add_u32 m0, s70, 73728
    s_nop 0
    buffer_load_dwordx4 v7, s[52:55], s69 offen nt lds
    s_add_u32 m0, s70, 74752
    s_add_u32 s69, s69, 8192
    buffer_load_dwordx4 v7, s[52:55], s69 offen nt lds
    s_add_u32 m0, s70, 75776
    s_add_u32 s69, s69, 8192
    buffer_load_dwordx4 v7, s[52:55], s69 offen nt lds
    s_add_u32 m0, s70, 76800
    s_add_u32 s69, s69, 8192
    buffer_load_dwordx4 v7, s[52:55], s69 offen nt lds
    s_add_u32 s69, s68, 384
    s_add_u32 m0, s70, 77824
    s_nop 0
    buffer_load_dwordx4 v7, s[52:55], s69 offen nt lds
    s_add_u32 m0, s70, 78848
    s_add_u32 s69, s69, 8192
    buffer_load_dwordx4 v7, s[52:55], s69 offen nt lds
    s_add_u32 m0, s70, 79872
    s_add_u32 s69, s69, 8192
    buffer_load_dwordx4 v7, s[52:55], s69 offen nt lds
    s_add_u32 m0, s70, 80896
    s_add_u32 s69, s69, 8192
    buffer_load_dwordx4 v7, s[52:55], s69 offen nt lds
    s_waitcnt vmcnt(16)
    s_barrier
    s_branch L_f1
L_ga_L:
    s_mov_b32 s56, s14
    s_and_b32 s57, s15, 0xffff
    s_mov_b32 s58, 4194304
    s_mov_b32 s59, 0x20000
    s_mov_b32 m0, s70
    s_nop 0
    buffer_load_dwordx4 v32, s[56:59], s68 offen nt lds
    s_add_u32 m0, s70, 1024
    s_add_u32 s68, s68, 16384
    buffer_load_dwordx4 v33, s[56:59], s68 offen nt lds
    s_add_u32 m0, s70, 2048
    s_add_u32 s68, s68, 16384
    buffer_load_dwordx4 v34, s[56:59], s68 offen nt lds
    s_add_u32 m0, s70, 3072
    s_add_u32 s68, s68, 16384
    buffer_load_dwordx4 v35, s[56:59], s68 offen nt lds
    s_add_u32 m0, s70, 4096
    s_add_u32 s68, s68, 16384
    buffer_load_dwordx4 v32, s[56:59], s68 offen nt lds
    s_add_u32 m0, s70, 5120
    s_add_u32 s68, s68, 16384
    buffer_load_dwordx4 v33, s[56:59], s68 offen nt lds
    s_add_u32 m0, s70, 6144
    s_add_u32 s68, s68, 16384
    buffer_load_dwordx4 v34, s[56:59], s68 offen nt lds
    s_add_u32 m0, s70, 7168
    s_add_u32 s68, s68, 16384
    buffer_load_dwordx4 v35, s[56:59], s68 offen nt lds
    s_add_u32 m0, s70, 8192
    s_add_u32 s68, s68, 16384
    buffer_load_dwordx4 v32, s[56:59], s68 offen nt lds
    s_add_u32 m0, s70, 9216
    s_add_u32 s68, s68, 16384
    buffer_load_dwordx4 v33, s[56:59], s68 offen nt lds
    s_add_u32 m0, s70, 10240
    s_add_u32 s68, s68, 16384
    buffer_load_dwordx4 v34, s[56:59], s68 offen nt lds
    s_add_u32 m0, s70, 11264
    s_add_u32 s68, s68, 16384
    buffer_load_dwordx4 v35, s[56:59], s68 offen nt lds
    s_add_u32 m0, s70, 12288
    s_add_u32 s68, s68, 16384
    buffer_load_dwordx4 v32, s[56:59], s68 offen nt lds
    s_add_u32 m0, s70, 13312
    s_add_u32 s68, s68, 16384
    buffer_load_dwordx4 v33, s[56:59], s68 offen nt lds
    s_add_u32 m0, s70, 14336
    s_add_u32 s68, s68, 16384
    buffer_load_dwordx4 v34, s[56:59], s68 offen nt lds
    s_add_u32 m0, s70, 15360
    s_add_u32 s68, s68, 16384
    buffer_load_dwordx4 v35, s[56:59], s68 offen nt lds
    s_barrier
    s_mov_b32 s60, s34
    s_and_b32 s61, s35, 0xffff
    s_mov_b32 s62, 2097152
    s_mov_b32 s63, 0x20000
    s_waitcnt lgkmcnt(0)
    s_add_u32 s39, s39, 0x01010101
    s_lshl_b32 s41, s71, 2
    s_add_u32 s41, s41, 133136
    v_mov_b32 v22, s41
    v_mov_b32 v23, s39
    ds_write_b32 v22, v23
    v_lshrrev_b32 v44, 2, v0
    v_and_b32 v45, 7, v44
    v_lshlrev_b32 v44, 9, v44
    v_and_b32 v46, 3, v0
    v_lshl_add_u32 v44, v46, 3, v44
    s_lshl_b32 s41, s71, 2
    s_add_u32 s42, s41, 0
    v_xor_b32 v46, s42, v45
    v_lshl_add_u32 v40, v46, 5, v44
    s_add_u32 s42, s41, 1
    v_xor_b32 v46, s42, v45
    v_lshl_add_u32 v41, v46, 5, v44
    s_add_u32 s42, s41, 2
    v_xor_b32 v46, s42, v45
    v_lshl_add_u32 v42, v46, 5, v44
    s_add_u32 s42, s41, 3
    v_xor_b32 v46, s42, v45
    v_lshl_add_u32 v43, v46, 5, v44
    v_lshlrev_b32 v45, 4, v2
    v_add_u32 v45, 131072, v45
    v_mov_b32 v46, 133632
    v_lshrrev_b32 v44, 2, v1
    v_cmp_eq_u32 s[80:81], 0, v44
    s_nop 1
    v_cndmask_b32 v48, v46, v45, s[80:81]
    v_cmp_eq_u32 s[80:81], 1, v44
    s_nop 1
    v_cndmask_b32 v49, v46, v45, s[80:81]
    v_cmp_eq_u32 s[80:81], 2, v44
    s_nop 1
    v_cndmask_b32 v50, v46, v45, s[80:81]
    v_cmp_eq_u32 s[80:81], 3, v44
    s_nop 1
    v_cndmask_b32 v51, v46, v45, s[80:81]
    s_lshl_b32 s41, s72, 15
    s_lshl_b32 s42, s36, 12
    s_add_u32 s41, s41, s42
    s_lshl_b32 s42, s73, 11
    s_add_u32 s41, s41, s42
    s_lshl_b32 s42, s71, 9
    s_add_u32 s41, s41, s42
    s_add_u32 s41, s41, 1507328
    v_lshl_add_u32 v21, v0, 3, s41
    s_mov_b32 s74, 131072
    s_lshl_b32 s41, s71, 2
    s_add_u32 s41, s41, 133120
    v_mov_b32 v52, 133120
    s_waitcnt vmcnt(0)
    v_mov_b32 v54, s41
    v_mov_b32 v55, s39
    ds_write_b32 v54, v55
    s_mov_b32 s7, 0
L_poll_17:
    ds_read_b128 v[28:31], v52
    s_waitcnt lgkmcnt(0)
    v_xor_b32 v28, s39, v28
    v_xor_b32 v29, s39, v29
    v_xor_b32 v30, s39, v30
    v_xor_b32 v31, s39, v31
    v_or3_b32 v28, v28, v29, v30
    v_or_b32 v28, v28, v31
    v_cmp_ne_u32 vcc, 0, v28
    s_cbranch_vccz L_ok_18
    s_add_u32 s7, s7, 1
    s_cmp_lt_u32 s7, 200000
    s_cbranch_scc1 L_poll_17
    s_branch L_end
L_ok_18:
    ds_read_b64_tr_b16 v[64:65], v40 offset:0
    ds_read_b64_tr_b16 v[66:67], v40 offset:8192
    ds_read_b64_tr_b16 v[68:69], v40 offset:16384
    ds_read_b64_tr_b16 v[70:71], v40 offset:24576
    ds_read_b64_tr_b16 v[72:73], v40 offset:32768
    ds_read_b64_tr_b16 v[74:75], v40 offset:40960
    ds_read_b64_tr_b16 v[76:77], v40 offset:49152
    ds_read_b64_tr_b16 v[78:79], v40 offset:57344
    ds_read_b64_tr_b16 v[80:81], v41 offset:0
    ds_read_b64_tr_b16 v[82:83], v41 offset:8192
    ds_read_b64_tr_b16 v[84:85], v41 offset:16384
    ds_read_b64_tr_b16 v[86:87], v41 offset:24576
    ds_read_b64_tr_b16 v[88:89], v41 offset:32768
    ds_read_b64_tr_b16 v[90:91], v41 offset:40960
    ds_read_b64_tr_b16 v[92:93], v41 offset:49152
    ds_read_b64_tr_b16 v[94:95], v41 offset:57344
    ds_read_b64_tr_b16 v[96:97], v42 offset:0
    ds_read_b64_tr_b16 v[98:99], v42 offset:8192
    ds_read_b64_tr_b16 v[100:101], v42 offset:16384
    ds_read_b64_tr_b16 v[102:103], v42 offset:24576
    ds_read_b64_tr_b16 v[104:105], v42 offset:32768
    ds_read_b64_tr_b16 v[106:107], v42 offset:40960
    ds_read_b64_tr_b16 v[108:109], v42 offset:49152
    ds_read_b64_tr_b16 v[110:111], v42 offset:57344
    ds_read_b64_tr_b16 v[112:113], v43 offset:0
    ds_read_b64_tr_b16 v[114:115], v43 offset:8192
    ds_read_b64_tr_b16 v[116:117], v43 offset:16384
    ds_read_b64_tr_b16 v[118:119], v43 offset:24576
    ds_read_b64_tr_b16 v[120:121], v43 offset:32768
    ds_read_b64_tr_b16 v[122:123], v43 offset:40960
    ds_read_b64_tr_b16 v[124:125], v43 offset:49152
    ds_read_b64_tr_b16 v[126:127], v43 offset:57344
    v_mov_b32 v52, 133168
    s_mov_b32 s7, 0
L_poll_19:
    ds_read_b64 v[28:29], v52
    s_waitcnt lgkmcnt(0)
    v_xor_b32 v28, s39, v28
    v_xor_b32 v29, s39, v29
    v_or_b32 v28, v28, v29
    v_cmp_ne_u32 vcc, 0, v28
    s_cbranch_vccz L_ok_20
    s_add_u32 s7, s7, 1
    s_cmp_lt_u32 s7, 200000
    s_cbranch_scc1 L_poll_19
    s_branch L_end
L_ok_20:
    ds_read_b128 v[24:27], v48 offset:0
    ds_read_b128 v[28:31], v49 offset:0
    ds_read_b128 v[32:35], v50 offset:0
    ds_read_b128 v[36:39], v51 offset:0
    ds_read_b128 v[128:131], v48 offset:64
    ds_read_b128 v[132:135], v49 offset:64
    ds_read_b128 v[136:139], v50 offset:64
    ds_read_b128 v[140:143], v51 offset:64
    s_waitcnt lgkmcnt(7)
    v_mfma_f32_16x16x32_bf16 v[56:59], v[24:27], v[64:67], 0
    ds_read_b128 v[24:27], v48 offset:128
    s_waitcnt lgkmcnt(7)
    v_mfma_f32_16x16x32_bf16 v[56:59], v[28:31], v[80:83], v[56:59]
    ds_read_b128 v[28:31], v49 offset:128
    s_waitcnt lgkmcnt(7)
    v_mfma_f32_16x16x32_bf16 v[56:59], v[32:35], v[96:99], v[56:59]
    ds_read_b128 v[32:35], v50 offset:128
    s_waitcnt lgkmcnt(7)
    v_mfma_f32_16x16x32_bf16 v[56:59], v[36:39], v[112:115], v[56:59]
    ds_read_b128 v[36:39], v51 offset:128
    s_waitcnt lgkmcnt(7)
    v_mfma_f32_16x16x32_bf16 v[56:59], v[128:131], v[68:71], v[56:59]
    ds_read_b128 v[128:131], v48 offset:192
    s_waitcnt lgkmcnt(7)
    v_mfma_f32_16x16x32_bf16 v[56:59], v[132:135], v[84:87], v[56:59]
    ds_read_b128 v[132:135], v49 offset:192
    s_waitcnt lgkmcnt(7)
    v_mfma_f32_16x16x32_bf16 v[56:59], v[136:139], v[100:103], v[56:59]
    ds_read_b128 v[136:139], v50 offset:192
    s_waitcnt lgkmcnt(7)
    v_mfma_f32_16x16x32_bf16 v[56:59], v[140:143], v[116:119], v[56:59]
    ds_read_b128 v[140:143], v51 offset:192
    s_waitcnt lgkmcnt(7)
    v_mfma_f32_16x16x32_bf16 v[56:59], v[24:27], v[72:75], v[56:59]
    s_waitcnt lgkmcnt(6)
    v_mfma_f32_16x16x32_bf16 v[56:59], v[28:31], v[88:91], v[56:59]
    s_waitcnt lgkmcnt(5)
    v_mfma_f32_16x16x32_bf16 v[56:59], v[32:35], v[104:107], v[56:59]
    s_waitcnt lgkmcnt(4)
    v_mfma_f32_16x16x32_bf16 v[56:59], v[36:39], v[120:123], v[56:59]
    s_waitcnt lgkmcnt(3)
    v_mfma_f32_16x16x32_bf16 v[56:59], v[128:131], v[76:79], v[56:59]
    s_waitcnt lgkmcnt(2)
    v_mfma_f32_16x16x32_bf16 v[56:59], v[132:135], v[92:95], v[56:59]
    s_waitcnt lgkmcnt(1)
    v_mfma_f32_16x16x32_bf16 v[56:59], v[136:139], v[108:111], v[56:59]
    s_waitcnt lgkmcnt(0)
    v_mfma_f32_16x16x32_bf16 v[56:59], v[140:143], v[124:127], v[56:59]
    s_nop 7
    v_mov_b32 v57, s39
    buffer_store_dwordx2 v[56:57], v21, s[60:63], s74 offen
    buffer_store_dwordx2 v[56:57], v21, s[60:63], 0 offen sc1
    s_lshl_b32 s41, s71, 2
    s_add_u32 s41, s41, 133184
    v_mov_b32 v52, s41
    v_mov_b32 v53, s39
    ds_write_b32 v52, v53
    s_mov_b32 s76, s39
    s_lshr_b32 s77, s39, 8
    s_lshr_b32 s78, s39, 16
    s_lshr_b32 s79, s39, 24
    v_mov_b32 v158, 0x0c0c0400
    v_mov_b32 v159, 0x04000c0c
    v_mov_b32 v157, 0xff
    v_and_b32 v44, 3, v0
    v_lshlrev_b32 v44, 3, v44
    v_lshrrev_b32 v156, v44, s39
    s_lshl_b32 s41, s38, 8
    s_add_u32 s41, s41, 393216
    v_lshl_add_u32 v144, v1, 4, s41
    v_lshl_add_u32 v144, v2, 11, v144
    v_add_u32 v145, 8192, v144
    s_lshl_b32 s41, s38, 3
    s_add_u32 s41, s41, 132096
    v_mov_b32 v146, s41
    v_mov_b32 v147, 132096
    s_lshl_b32 s41, s38, 7
    s_add_u32 s41, s41, 131072
    v_lshrrev_b32 v148, 3, v1
    v_lshlrev_b32 v148, 6, v148
    v_and_b32 v44, 3, v1
    v_lshl_add_u32 v148, v44, 4, v148
    v_bfe_u32 v44, v1, 2, 1
    v_lshl_add_u32 v148, v44, 3, v148
    v_add_u32 v148, s41, v148
    v_lshlrev_b32 v149, 4, v2
    v_add_u32 v149, 131072, v149
    s_lshl_b32 s41, s38, 1
    v_add_u32 v150, s41, v2
    v_and_b32 v150, 3, v150
    v_lshlrev_b32 v150, 4, v150
    s_lshr_b32 s41, s38, 1
    s_and_b32 s41, s41, 1
    s_lshl_b32 s41, s41, 3
    s_add_u32 s41, s41, 132160
    v_add_u32 v150, s41, v150
    v_lshlrev_b32 v45, 4, v2
    v_add_u32 v45, 132160, v45
    v_mov_b32 v46, 132224
    v_lshrrev_b32 v44, 2, v1
    v_cmp_eq_u32 s[80:81], 0, v44
    s_nop 1
    v_cndmask_b32 v151, v46, v45, s[80:81]
    v_cmp_eq_u32 s[80:81], 1, v44
    s_nop 1
    v_cndmask_b32 v152, v46, v45, s[80:81]
    v_cmp_eq_u32 s[80:81], 2, v44
    s_nop 1
    v_cndmask_b32 v153, v46, v45, s[80:81]
    v_cmp_eq_u32 s[80:81], 3, v44
    s_nop 1
    v_cndmask_b32 v154, v46, v45, s[80:81]
    s_lshl_b32 s41, s6, 11
    s_lshl_b32 s42, s38, 8
    s_add_u32 s41, s41, s42
    s_add_u32 s41, s41, 458752
    v_lshl_add_u32 v155, v0, 2, s41
    v_mov_b32 v48, 0
    v_mov_b32 v49, 0
    v_mov_b32 v50, 0
    v_mov_b32 v51, 0
    ds_write_b128 v46, v[48:51]
L_f0:
    s_cmp_eq_u32 s43, 7
    s_cbranch_scc1 L_ga_done
    s_waitcnt vmcnt(0) lgkmcnt(0)
    s_barrier
L_f1:
    v_lshrrev_b32 v40, 2, v0
    v_bfe_u32 v44, v0, 1, 1
    v_and_b32 v45, 1, v2
    v_lshl_or_b32 v45, v45, 1, v44
    v_xor_b32 v45, s38, v45
    v_lshlrev_b32 v45, 4, v45
    v_lshl_add_u32 v45, v40, 6, v45
    v_and_b32 v46, 1, v0
    v_lshl_add_u32 v45, v46, 3, v45
    v_lshl_add_u32 v184, v44, 15, v45
    s_mov_b32 s64, s8
    s_and_b32 s65, s9, 0xffff
    s_mov_b32 s66, 1024
    s_mov_b32 s67, 0x20000
    s_lshl_b32 s41, s38, 7
    v_lshl_add_u32 v5, v1, 3, s41
    buffer_load_dwordx2 v[10:11], v5, s[64:67], 0 offen
    s_lshl_b32 s41, s38, 8
    s_add_u32 s42, s41, 8192
    v_lshl_add_u32 v5, v1, 4, s42
    v_add_u32 v6, 4096, v5
    buffer_load_dwordx4 v[12:15], v5, s[60:63], 0 offen offset:0 sc1
    buffer_load_dwordx4 v[16:19], v5, s[60:63], 0 offen offset:2048 sc1
    buffer_load_dwordx4 v[20:23], v6, s[60:63], 0 offen offset:0 sc1
    s_cmp_lt_u32 s38, 4
    s_cbranch_scc0 L_gufr_21
    ds_read_b64_tr_b16 v[64:65], v184 offset:0
    ds_read_b64_tr_b16 v[66:67], v184 offset:1024
    ds_read_b64_tr_b16 v[68:69], v184 offset:2048
    ds_read_b64_tr_b16 v[70:71], v184 offset:3072
    ds_read_b64_tr_b16 v[72:73], v184 offset:4096
    ds_read_b64_tr_b16 v[74:75], v184 offset:5120
    ds_read_b64_tr_b16 v[76:77], v184 offset:6144
    ds_read_b64_tr_b16 v[78:79], v184 offset:7168
    ds_read_b64_tr_b16 v[80:81], v184 offset:8192
    ds_read_b64_tr_b16 v[82:83], v184 offset:9216
    ds_read_b64_tr_b16 v[84:85], v184 offset:10240
    ds_read_b64_tr_b16 v[86:87], v184 offset:11264
    ds_read_b64_tr_b16 v[88:89], v184 offset:12288
    ds_read_b64_tr_b16 v[90:91], v184 offset:13312
    ds_read_b64_tr_b16 v[92:93], v184 offset:14336
    ds_read_b64_tr_b16 v[94:95], v184 offset:15360
    ds_read_b64_tr_b16 v[96:97], v184 offset:16384
    ds_read_b64_tr_b16 v[98:99], v184 offset:17408
    ds_read_b64_tr_b16 v[100:101], v184 offset:18432
    ds_read_b64_tr_b16 v[102:103], v184 offset:19456
    ds_read_b64_tr_b16 v[104:105], v184 offset:20480
    ds_read_b64_tr_b16 v[106:107], v184 offset:21504
    ds_read_b64_tr_b16 v[108:109], v184 offset:22528
    ds_read_b64_tr_b16 v[110:111], v184 offset:23552
    ds_read_b64_tr_b16 v[112:113], v184 offset:24576
    ds_read_b64_tr_b16 v[114:115], v184 offset:25600
    ds_read_b64_tr_b16 v[116:117], v184 offset:26624
    ds_read_b64_tr_b16 v[118:119], v184 offset:27648
    ds_read_b64_tr_b16 v[120:121], v184 offset:28672
    ds_read_b64_tr_b16 v[122:123], v184 offset:29696
    ds_read_b64_tr_b16 v[124:125], v184 offset:30720
    ds_read_b64_tr_b16 v[126:127], v184 offset:31744
L_gufr_21:
    s_waitcnt vmcnt(0)
    v_xor_b32 v24, s39, v13
    v_xor_b32 v25, s39, v15
    v_or_b32 v24, v24, v25
    v_xor_b32 v25, s39, v17
    v_or_b32 v24, v24, v25
    v_xor_b32 v25, s39, v19
    v_or_b32 v24, v24, v25
    v_xor_b32 v25, s39, v21
    v_or_b32 v24, v24, v25
    v_xor_b32 v25, s39, v23
    v_or_b32 v24, v24, v25
    v_cmp_ne_u32 vcc, 0, v24
    s_cbranch_vccz L_mbok_23
    s_mov_b32 s7, 0
L_poll_24:
    buffer_load_dwordx4 v[12:15], v5, s[60:63], 0 offen offset:0 sc1
    buffer_load_dwordx4 v[16:19], v5, s[60:63], 0 offen offset:2048 sc1
    buffer_load_dwordx4 v[20:23], v6, s[60:63], 0 offen offset:0 sc1
    s_waitcnt vmcnt(0)
    v_xor_b32 v24, s39, v13
    v_xor_b32 v25, s39, v15
    v_or_b32 v24, v24, v25
    v_xor_b32 v25, s39, v17
    v_or_b32 v24, v24, v25
    v_xor_b32 v25, s39, v19
    v_or_b32 v24, v24, v25
    v_xor_b32 v25, s39, v21
    v_or_b32 v24, v24, v25
    v_xor_b32 v25, s39, v23
    v_or_b32 v24, v24, v25
    v_cmp_ne_u32 vcc, 0, v24
    s_cbranch_vccz L_ok_25
    s_add_u32 s7, s7, 1
    s_cmp_lt_u32 s7, 200000
    s_cbranch_scc1 L_poll_24
    s_branch L_end
L_ok_25:
L_mbok_23:
    v_lshlrev_b32 v128, 16, v12
    v_and_b32 v129, 0xffff0000, v12
    v_lshlrev_b32 v130, 16, v14
    v_and_b32 v131, 0xffff0000, v14
    v_lshlrev_b32 v132, 16, v16
    v_and_b32 v133, 0xffff0000, v16
    v_lshlrev_b32 v134, 16, v18
    v_and_b32 v135, 0xffff0000, v18
    v_lshlrev_b32 v136, 16, v20
    v_and_b32 v137, 0xffff0000, v20
    v_lshlrev_b32 v138, 16, v22
    v_and_b32 v139, 0xffff0000, v22
    v_pk_add_f32 v[136:137], v[136:137], 1.0 op_sel_hi:[1,0]
    v_pk_add_f32 v[138:139], v[138:139], 1.0 op_sel_hi:[1,0]
    v_cvt_pk_bf16_f32 v40, v136, v137
    v_lshlrev_b32 v136, 16, v40
    v_and_b32 v137, 0xffff0000, v40
    v_cvt_pk_bf16_f32 v40, v138, v139
    v_lshlrev_b32 v138, 16, v40
    v_and_b32 v139, 0xffff0000, v40
    v_lshlrev_b32 v140, 16, v10
    v_and_b32 v141, 0xffff0000, v10
    v_lshlrev_b32 v142, 16, v11
    v_and_b32 v143, 0xffff0000, v11
    s_lshl_b32 s41, s38, 12
    s_add_u32 s41, s41, 65536
    v_lshrrev_b32 v40, 2, v0
    v_lshlrev_b32 v41, 7, v40
    v_and_b32 v42, 3, v0
    v_lshl_add_u32 v41, v42, 3, v41
    v_add_u32 v41, s41, v41
    v_bfe_u32 v43, v0, 3, 2
    v_xor_b32 v46, 0, v43
    v_lshl_add_u32 v185, v46, 5, v41
    v_xor_b32 v46, 1, v43
    v_lshl_add_u32 v186, v46, 5, v41
    v_xor_b32 v46, 2, v43
    v_lshl_add_u32 v187, v46, 5, v41
    v_xor_b32 v46, 3, v43
    v_lshl_add_u32 v188, v46, 5, v41
    s_waitcnt lgkmcnt(0)
    s_mov_b32 s7, 0
L_poll_26:
    buffer_load_dwordx4 v[12:15], v144, s[60:63], 0 offen sc1
    buffer_load_dwordx4 v[16:19], v145, s[60:63], 0 offen sc1
    s_waitcnt vmcnt(0)
    v_perm_b32 v45, v13, v12, v158
    v_perm_b32 v46, v15, v14, v159
    v_bitop3_b32 v44, v45, v46, s39 bitop3:0x56
    v_perm_b32 v45, v17, v16, v158
    v_perm_b32 v46, v19, v18, v159
    v_bitop3_b32 v45, v45, v46, s39 bitop3:0x56
    v_or_b32 v44, v44, v45
    v_cmp_ne_u32 vcc, 0, v44
    s_cbranch_vccz L_ok_27
    s_add_u32 s7, s7, 1
    s_cmp_lt_u32 s7, 200000
    s_cbranch_scc1 L_poll_26
    s_branch L_end
L_ok_27:
    v_and_b32 v12, 0xffffff00, v12
    v_and_b32 v13, 0xffffff00, v13
    v_and_b32 v14, 0xffffff00, v14
    v_and_b32 v15, 0xffffff00, v15
    v_and_b32 v16, 0xffffff00, v16
    v_and_b32 v17, 0xffffff00, v17
    v_and_b32 v18, 0xffffff00, v18
    v_and_b32 v19, 0xffffff00, v19
    v_pk_add_f32 v[12:13], v[12:13], v[16:17]
    v_pk_add_f32 v[14:15], v[14:15], v[18:19]
    v_mov_b32 v16, v12
    v_mov_b32 v17, v13
    v_mov_b32 v18, v14
    v_mov_b32 v19, v15
    v_permlane16_swap_b32 v12, v16
    v_permlane16_swap_b32 v13, v17
    v_permlane16_swap_b32 v14, v18
    v_permlane16_swap_b32 v15, v19
    v_add_f32 v12, v12, v16
    v_add_f32 v13, v13, v17
    v_add_f32 v14, v14, v18
    v_add_f32 v15, v15, v19
    v_mov_b32 v16, v12
    v_mov_b32 v17, v13
    v_mov_b32 v18, v14
    v_mov_b32 v19, v15
    v_permlane32_swap_b32 v12, v16
    v_permlane32_swap_b32 v13, v17
    v_permlane32_swap_b32 v14, v18
    v_permlane32_swap_b32 v15, v19
    v_add_f32 v12, v12, v16
    v_add_f32 v13, v13, v17
    v_add_f32 v14, v14, v18
    v_add_f32 v15, v15, v19
    v_fma_f32 v12, v128, v12, v140
    v_fma_f32 v13, v129, v13, v141
    v_fma_f32 v14, v130, v14, v142
    v_fma_f32 v15, v131, v15, v143
    v_cvt_pk_bf16_f32 v44, v12, v13
    v_lshlrev_b32 v12, 16, v44
    v_and_b32 v13, 0xffff0000, v44
    v_cvt_pk_bf16_f32 v45, v14, v15
    v_lshlrev_b32 v14, 16, v45
    v_and_b32 v15, 0xffff0000, v45
    v_add_f32 v16, v12, v13
    v_add_f32 v18, v14, v15
    v_mul_f32 v17, v12, v12
    v_add_f32 v16, v16, v18
    v_fmac_f32 v17, v13, v13
    v_fmac_f32 v17, v14, v14
    v_fmac_f32 v17, v15, v15
    s_nop 0
    v_add_f32_dpp v16, v16, v16 row_ror:8 row_mask:0xf bank_mask:0xf
    v_add_f32_dpp v17, v17, v17 row_ror:8 row_mask:0xf bank_mask:0xf
    s_nop 0
    v_add_f32_dpp v16, v16, v16 row_ror:4 row_mask:0xf bank_mask:0xf
    v_add_f32_dpp v17, v17, v17 row_ror:4 row_mask:0xf bank_mask:0xf
    s_nop 0
    v_add_f32_dpp v16, v16, v16 row_ror:2 row_mask:0xf bank_mask:0xf
    v_add_f32_dpp v17, v17, v17 row_ror:2 row_mask:0xf bank_mask:0xf
    s_nop 0
    v_add_f32_dpp v16, v16, v16 row_ror:1 row_mask:0xf bank_mask:0xf
    v_add_f32_dpp v17, v17, v17 row_ror:1 row_mask:0xf bank_mask:0xf
    s_nop 0
    ds_write_b64 v146, v[16:17]
    s_waitcnt lgkmcnt(0)
    s_barrier
    ds_read_b128 v[16:19], v147
    ds_read_b128 v[24:27], v147 offset:16
    ds_read_b128 v[44:47], v147 offset:32
    ds_read_b128 v[4:7], v147 offset:48
    ds_read_b64_tr_b16 v[168:169], v185 offset:0
    ds_read_b64_tr_b16 v[170:171], v185 offset:2048
    ds_read_b64_tr_b16 v[172:173], v186 offset:0
    ds_read_b64_tr_b16 v[174:175], v186 offset:2048
    ds_read_b64_tr_b16 v[176:177], v187 offset:0
    ds_read_b64_tr_b16 v[178:179], v187 offset:2048
    ds_read_b64_tr_b16 v[180:181], v188 offset:0
    ds_read_b64_tr_b16 v[182:183], v188 offset:2048
    s_waitcnt lgkmcnt(8)
    v_pk_add_f32 v[16:17], v[16:17], v[18:19]
    v_pk_add_f32 v[24:25], v[24:25], v[26:27]
    v_pk_add_f32 v[44:45], v[44:45], v[46:47]
    v_pk_add_f32 v[4:5], v[4:5], v[6:7]
    v_pk_add_f32 v[16:17], v[16:17], v[24:25]
    v_pk_add_f32 v[44:45], v[44:45], v[4:5]
    v_pk_add_f32 v[16:17], v[16:17], v[44:45]
    v_mul_f32 v16, 0x3b000000, v16
    v_mul_f32 v17, 0x3b000000, v17
    v_fma_f32 v17, -v16, v16, v17
    v_max_f32 v17, 0, v17
    v_cvt_pk_bf16_f32 v19, v16, v17
    v_lshlrev_b32 v16, 16, v19
    v_and_b32 v17, 0xffff0000, v19
    v_add_f32 v17, 0x3727c5ac, v17
    v_cvt_pk_bf16_f32 v19, v17, v17
    v_lshlrev_b32 v17, 16, v19
    v_sqrt_f32 v17, v17
    s_nop 0
    v_cvt_pk_bf16_f32 v19, v17, v17
    v_lshlrev_b32 v17, 16, v19
    v_rcp_f32 v18, v17
    s_nop 0
    v_sub_f32 v12, v12, v16
    v_sub_f32 v13, v13, v16
    v_sub_f32 v14, v14, v16
    v_sub_f32 v15, v15, v16
    v_pk_mul_f32 v[136:137], v[136:137], v[18:19] op_sel_hi:[1,0]
    v_pk_mul_f32 v[138:139], v[138:139], v[18:19] op_sel_hi:[1,0]
    v_pk_fma_f32 v[12:13], v[12:13], v[136:137], v[132:133]
    v_pk_fma_f32 v[14:15], v[14:15], v[138:139], v[134:135]
    v_cvt_pk_bf16_f32 v12, v12, v13
    v_cvt_pk_bf16_f32 v13, v14, v15
    ds_write_b64 v148, v[12:13]
    s_waitcnt lgkmcnt(0)
    s_barrier
    s_cmp_lt_u32 s38, 4
    s_cbranch_scc0 L_gu_28
    ds_read_b128 v[24:27], v149 offset:0
    ds_read_b128 v[28:31], v149 offset:64
    ds_read_b128 v[32:35], v149 offset:128
    ds_read_b128 v[36:39], v149 offset:192
    ds_read_b128 v[40:43], v149 offset:256
    ds_read_b128 v[44:47], v149 offset:320
    ds_read_b128 v[48:51], v149 offset:384
    ds_read_b128 v[52:55], v149 offset:448
    s_waitcnt lgkmcnt(7)
    v_mfma_f32_16x16x32_bf16 v[56:59], v[64:67], v[24:27], 0
    ds_read_b128 v[24:27], v149 offset:512
    s_waitcnt lgkmcnt(7)
    v_mfma_f32_16x16x32_bf16 v[56:59], v[68:71], v[28:31], v[56:59]
    ds_read_b128 v[28:31], v149 offset:576
    s_waitcnt lgkmcnt(7)
    v_mfma_f32_16x16x32_bf16 v[56:59], v[72:75], v[32:35], v[56:59]
    ds_read_b128 v[32:35], v149 offset:640
    s_waitcnt lgkmcnt(7)
    v_mfma_f32_16x16x32_bf16 v[56:59], v[76:79], v[36:39], v[56:59]
    ds_read_b128 v[36:39], v149 offset:704
    s_waitcnt lgkmcnt(7)
    v_mfma_f32_16x16x32_bf16 v[56:59], v[80:83], v[40:43], v[56:59]
    ds_read_b128 v[40:43], v149 offset:768
    s_waitcnt lgkmcnt(7)
    v_mfma_f32_16x16x32_bf16 v[56:59], v[84:87], v[44:47], v[56:59]
    ds_read_b128 v[44:47], v149 offset:832
    s_waitcnt lgkmcnt(7)
    v_mfma_f32_16x16x32_bf16 v[56:59], v[88:91], v[48:51], v[56:59]
    ds_read_b128 v[48:51], v149 offset:896
    s_waitcnt lgkmcnt(7)
    v_mfma_f32_16x16x32_bf16 v[56:59], v[92:95], v[52:55], v[56:59]
    ds_read_b128 v[52:55], v149 offset:960
    s_waitcnt lgkmcnt(7)
    v_mfma_f32_16x16x32_bf16 v[56:59], v[96:99], v[24:27], v[56:59]
    s_waitcnt lgkmcnt(6)
    v_mfma_f32_16x16x32_bf16 v[56:59], v[100:103], v[28:31], v[56:59]
    s_waitcnt lgkmcnt(5)
    v_mfma_f32_16x16x32_bf16 v[56:59], v[104:107], v[32:35], v[56:59]
    s_waitcnt lgkmcnt(4)
    v_mfma_f32_16x16x32_bf16 v[56:59], v[108:111], v[36:39], v[56:59]
    s_waitcnt lgkmcnt(3)
    v_mfma_f32_16x16x32_bf16 v[56:59], v[112:115], v[40:43], v[56:59]
    s_waitcnt lgkmcnt(2)
    v_mfma_f32_16x16x32_bf16 v[56:59], v[116:119], v[44:47], v[56:59]
    s_waitcnt lgkmcnt(1)
    v_mfma_f32_16x16x32_bf16 v[56:59], v[120:123], v[48:51], v[56:59]
    s_waitcnt lgkmcnt(0)
    v_mfma_f32_16x16x32_bf16 v[56:59], v[124:127], v[52:55], v[56:59]
    s_nop 7
    v_cvt_pk_bf16_f32 v12, v56, v57
    v_cvt_pk_bf16_f32 v13, v58, v59
    v_mov_b32 v14, v12
    v_mov_b32 v15, v13
    s_nop 0
    v_permlane32_swap_b32 v12, v14
    v_permlane32_swap_b32 v13, v15
    v_lshlrev_b32 v16, 16, v12
    v_and_b32 v17, 0xffff0000, v12
    v_lshlrev_b32 v18, 16, v13
    v_and_b32 v19, 0xffff0000, v13
    v_lshlrev_b32 v24, 16, v14
    v_and_b32 v25, 0xffff0000, v14
    v_lshlrev_b32 v26, 16, v15
    v_and_b32 v27, 0xffff0000, v15
    v_pk_mul_f32 v[16:17], v[16:17], v[24:25]
    v_pk_mul_f32 v[18:19], v[18:19], v[26:27]
    v_cvt_pk_bf16_f32 v16, v16, v17
    v_cvt_pk_bf16_f32 v17, v18, v19
    s_mov_b32 exec_lo, 0x00010001
    s_mov_b32 exec_hi, 0
    ds_write_b64 v150, v[16:17]
    s_mov_b64 exec, -1
    s_waitcnt lgkmcnt(0)
L_gu_28:
    s_barrier
    ds_read_b128 v[24:27], v151
    ds_read_b128 v[28:31], v152
    ds_read_b128 v[32:35], v153
    ds_read_b128 v[36:39], v154
    s_waitcnt lgkmcnt(3)
    v_mfma_f32_16x16x32_bf16 v[12:15], v[24:27], v[168:171], 0
    s_waitcnt lgkmcnt(2)
    v_mfma_f32_16x16x32_bf16 v[12:15], v[28:31], v[172:175], v[12:15]
    s_waitcnt lgkmcnt(1)
    v_mfma_f32_16x16x32_bf16 v[12:15], v[32:35], v[176:179], v[12:15]
    s_waitcnt lgkmcnt(0)
    v_mfma_f32_16x16x32_bf16 v[12:15], v[36:39], v[180:183], v[12:15]
    s_nop 7
    v_bfi_b32 v12, v157, v156, v12
    buffer_store_dword v12, v155, s[60:63], 0 offen sc1
L_ga_done:
    s_endpgm
L_gc:
    v_readfirstlane_b32 s38, v1
    v_mov_b32 v60, 117248
    v_mov_b32 v56, 0
    v_mov_b32 v57, 0
    v_mov_b32 v58, 0
    v_mov_b32 v59, 0
    ds_write_b128 v60, v[56:59] offset:0
    ds_write_b128 v60, v[56:59] offset:16
    ds_write_b128 v60, v[56:59] offset:32
    v_and_b32 v0, 63, v0
    v_and_b32 v1, 15, v0
    v_lshrrev_b32 v2, 4, v0
    s_sub_u32 s43, s37, 0
    s_lshl_b32 s40, s36, 3
    s_add_u32 s40, s40, s43
    v_bfe_u32 v8, v0, 1, 2
    v_and_b32 v9, 3, v2
    v_xor_b32 v8, v8, v9
    v_and_b32 v9, 1, v0
    v_lshl_or_b32 v8, v8, 1, v9
    v_lshlrev_b32 v8, 4, v8
    v_lshrrev_b32 v7, 3, v0
    v_mul_u32_u24 v7, 6144, v7
    v_add_u32 v7, v7, v8
    s_and_b32 s72, s40, 3
    s_lshr_b32 s73, s40, 2
    s_lshl_b32 s41, s72, 2
    s_add_u32 s41, s41, s38
    s_mul_i32 s68, s41, 196608
    s_lshl_b32 s42, s73, 7
    s_add_u32 s68, s68, s42
    s_lshl_b32 s70, s38, 12
    s_lshl_b32 s41, s41, 6
    v_and_b32 v3, 15, v0
    v_lshl_add_u32 v3, v3, 2, s41
    s_waitcnt lgkmcnt(0)
    s_load_dword s39, s[34:35], 0
    s_cmp_ge_u32 s38, 4
    s_cbranch_scc1 L_gc_L
    s_mov_b32 s48, s28
    s_and_b32 s49, s29, 0xffff
    s_mov_b32 s50, 3145728
    s_mov_b32 s51, 0x20000
    s_mov_b32 s44, s26
    s_and_b32 s45, s27, 0xffff
    s_mov_b32 s46, 1024
    s_mov_b32 s47, 0x20000
    buffer_load_dword v10, v3, s[44:47], 0 offen
    s_mov_b32 m0, s70
    s_nop 0
    buffer_load_dwordx4 v7, s[48:51], s68 offen nt lds
    s_add_u32 m0, s70, 1024
    s_add_u32 s68, s68, 49152
    buffer_load_dwordx4 v7, s[48:51], s68 offen nt lds
    s_add_u32 m0, s70, 2048
    s_add_u32 s68, s68, 49152
    buffer_load_dwordx4 v7, s[48:51], s68 offen nt lds
    s_add_u32 m0, s70, 3072
    s_add_u32 s68, s68, 49152
    buffer_load_dwordx4 v7, s[48:51], s68 offen nt lds
    s_barrier
    s_mov_b32 s60, s34
    s_and_b32 s61, s35, 0xffff
    s_mov_b32 s62, 2097152
    s_mov_b32 s63, 0x20000
    s_waitcnt lgkmcnt(0)
    s_add_u32 s39, s39, 0x01010101
    s_mov_b32 s76, s39
    s_lshr_b32 s77, s39, 8
    s_lshr_b32 s78, s39, 16
    s_lshr_b32 s79, s39, 24
    v_bfe_u32 v17, v0, 1, 2
    v_lshlrev_b32 v17, 4, v17
    v_bfe_u32 v18, v0, 3, 1
    v_lshl_add_u32 v17, v18, 3, v17
    v_and_b32 v18, 1, v0
    v_lshl_add_u32 v17, v18, 2, v17
    s_lshl_b32 s41, s38, 6
    s_add_u32 s41, s41, 114688
    v_add_u32 v18, s41, v17
    v_bfe_u32 v44, v0, 3, 2
    v_xor_b32 v44, s38, v44
    v_lshrrev_b32 v45, 2, v0
    v_lshlrev_b32 v45, 7, v45
    v_lshl_add_u32 v45, v44, 5, v45
    v_and_b32 v44, 3, v0
    v_lshl_add_u32 v20, v44, 3, v45
    v_add_u32 v20, 0, v20
    v_lshlrev_b32 v19, 4, v2
    v_add_u32 v19, 114688, v19
    s_lshl_b32 s41, s72, 13
    s_lshl_b32 s42, s73, 9
    s_add_u32 s41, s41, s42
    s_lshl_b32 s42, s38, 7
    s_add_u32 s41, s41, s42
    s_add_u32 s41, s41, 1441792
    v_lshl_add_u32 v23, v1, 3, s41
    s_lshl_b32 s41, s38, 2
    s_add_u32 s41, s41, 117248
    v_mov_b32 v14, s41
    v_mov_b32 v15, s39
    v_mov_b32 v16, 117248
    s_waitcnt vmcnt(4)
    v_lshlrev_b32 v22, 16, v10
    v_and_b32 v21, 0xffff0000, v10
    v_mul_f32 v24, 0xbfb8aa3b, v22
    v_mul_f32 v25, 0xbfb8aa3b, v21
    v_exp_f32 v24, v24
    v_exp_f32 v25, v25
    v_add_f32 v24, 1.0, v24
    v_add_f32 v25, 1.0, v25
    v_min_f32 v24, 0x7f7fffff, v24
    v_min_f32 v25, 0x7f7fffff, v25
    v_rcp_f32 v26, v24
    v_rcp_f32 v27, v25
    v_mul_f32 v28, v22, v26
    v_mul_f32 v29, v21, v27
    v_fma_f32 v24, -v24, v28, v22
    v_fma_f32 v25, -v25, v29, v21
    v_fma_f32 v22, v24, v26, v28
    v_fma_f32 v21, v25, v27, v29
    v_cvt_pk_bf16_f32 v22, v22, v21
    ds_write_b32 v18, v22
    s_waitcnt vmcnt(0)
    ds_write_b32 v14, v15
    s_mov_b32 s7, 0
L_poll_29:
    ds_read_b128 v[28:31], v16
    s_waitcnt lgkmcnt(0)
    v_xor_b32 v28, s39, v28
    v_xor_b32 v29, s39, v29
    v_xor_b32 v30, s39, v30
    v_xor_b32 v31, s39, v31
    v_or3_b32 v28, v28, v29, v30
    v_or_b32 v28, v28, v31
    v_cmp_ne_u32 vcc, 0, v28
    s_cbranch_vccz L_ok_30
    s_add_u32 s7, s7, 1
    s_cmp_lt_u32 s7, 200000
    s_cbranch_scc1 L_poll_29
    s_branch L_end
L_ok_30:
    ds_read_b64_tr_b16 v[40:41], v20 offset:0
    ds_read_b64_tr_b16 v[42:43], v20 offset:2048
    ds_read_b128 v[24:27], v19 offset:0
    ds_read_b64_tr_b16 v[44:45], v20 offset:4096
    ds_read_b64_tr_b16 v[46:47], v20 offset:6144
    ds_read_b128 v[28:31], v19 offset:64
    ds_read_b64_tr_b16 v[48:49], v20 offset:8192
    ds_read_b64_tr_b16 v[50:51], v20 offset:10240
    ds_read_b128 v[32:35], v19 offset:128
    ds_read_b64_tr_b16 v[52:53], v20 offset:12288
    ds_read_b64_tr_b16 v[54:55], v20 offset:14336
    ds_read_b128 v[36:39], v19 offset:192
    s_waitcnt lgkmcnt(9)
    v_mfma_f32_16x16x32_bf16 v[56:59], v[24:27], v[40:43], 0
    s_waitcnt lgkmcnt(6)
    v_mfma_f32_16x16x32_bf16 v[56:59], v[28:31], v[44:47], v[56:59]
    s_waitcnt lgkmcnt(3)
    v_mfma_f32_16x16x32_bf16 v[56:59], v[32:35], v[48:51], v[56:59]
    s_waitcnt lgkmcnt(0)
    v_mfma_f32_16x16x32_bf16 v[56:59], v[36:39], v[52:55], v[56:59]
    s_mov_b64 exec, 0xffff
    s_nop 6
    v_mov_b32 v57, s39
    buffer_store_dwordx2 v[56:57], v23, s[60:63], 0 offen sc1
    s_mov_b64 exec, -1
    s_barrier
    s_cmp_eq_u32 s38, 0
    s_cbranch_scc0 L_sk0_31
    v_lshlrev_b32 v3, 4, v0
    buffer_load_dwordx4 v[12:15], v3, s[44:47], 0 offen
    v_lshrrev_b32 v6, 2, v0
    v_lshlrev_b32 v6, 6, v6
    v_and_b32 v7, 1, v0
    v_lshl_add_u32 v6, v7, 5, v6
    v_bfe_u32 v7, v0, 1, 1
    v_lshl_add_u32 v6, v7, 3, v6
    v_add_u32 v6, 114944, v6
    s_waitcnt vmcnt(0)
    v_lshlrev_b32 v24, 16, v12
    v_and_b32 v25, 0xffff0000, v12
    v_lshlrev_b32 v26, 16, v13
    v_and_b32 v27, 0xffff0000, v13
    v_lshlrev_b32 v28, 16, v14
    v_and_b32 v29, 0xffff0000, v14
    v_lshlrev_b32 v30, 16, v15
    v_and_b32 v31, 0xffff0000, v15
    v_mul_f32 v32, 0xbfb8aa3b, v24
    v_mul_f32 v33, 0xbfb8aa3b, v25
    v_mul_f32 v34, 0xbfb8aa3b, v26
    v_mul_f32 v35, 0xbfb8aa3b, v27
    v_mul_f32 v36, 0xbfb8aa3b, v28
    v_mul_f32 v37, 0xbfb8aa3b, v29
    v_mul_f32 v38, 0xbfb8aa3b, v30
    v_mul_f32 v39, 0xbfb8aa3b, v31
    v_exp_f32 v32, v32
    v_exp_f32 v33, v33
    v_exp_f32 v34, v34
    v_exp_f32 v35, v35
    v_exp_f32 v36, v36
    v_exp_f32 v37, v37
    v_exp_f32 v38, v38
    v_exp_f32 v39, v39
    v_add_f32 v32, 1.0, v32
    v_add_f32 v33, 1.0, v33
    v_add_f32 v34, 1.0, v34
    v_add_f32 v35, 1.0, v35
    v_add_f32 v36, 1.0, v36
    v_add_f32 v37, 1.0, v37
    v_add_f32 v38, 1.0, v38
    v_add_f32 v39, 1.0, v39
    v_min_f32 v32, 0x7f7fffff, v32
    v_min_f32 v33, 0x7f7fffff, v33
    v_min_f32 v34, 0x7f7fffff, v34
    v_min_f32 v35, 0x7f7fffff, v35
    v_min_f32 v36, 0x7f7fffff, v36
    v_min_f32 v37, 0x7f7fffff, v37
    v_min_f32 v38, 0x7f7fffff, v38
    v_min_f32 v39, 0x7f7fffff, v39
    v_rcp_f32 v40, v32
    v_rcp_f32 v41, v33
    v_rcp_f32 v42, v34
    v_rcp_f32 v43, v35
    v_rcp_f32 v44, v36
    v_rcp_f32 v45, v37
    v_rcp_f32 v46, v38
    v_rcp_f32 v47, v39
    v_mul_f32 v48, v24, v40
    v_mul_f32 v49, v25, v41
    v_mul_f32 v50, v26, v42
    v_mul_f32 v51, v27, v43
    v_mul_f32 v52, v28, v44
    v_mul_f32 v53, v29, v45
    v_mul_f32 v54, v30, v46
    v_mul_f32 v55, v31, v47
    v_fma_f32 v32, -v32, v48, v24
    v_fma_f32 v33, -v33, v49, v25
    v_fma_f32 v34, -v34, v50, v26
    v_fma_f32 v35, -v35, v51, v27
    v_fma_f32 v36, -v36, v52, v28
    v_fma_f32 v37, -v37, v53, v29
    v_fma_f32 v38, -v38, v54, v30
    v_fma_f32 v39, -v39, v55, v31
    v_fma_f32 v24, v32, v40, v48
    v_fma_f32 v25, v33, v41, v49
    v_fma_f32 v26, v34, v42, v50
    v_fma_f32 v27, v35, v43, v51
    v_fma_f32 v28, v36, v44, v52
    v_fma_f32 v29, v37, v45, v53
    v_fma_f32 v30, v38, v46, v54
    v_fma_f32 v31, v39, v47, v55
    v_cvt_pk_bf16_f32 v24, v24, v25
    v_cvt_pk_bf16_f32 v25, v26, v27
    v_cvt_pk_bf16_f32 v26, v28, v29
    v_cvt_pk_bf16_f32 v27, v30, v31
    ds_write_b64 v6, v[24:25]
    ds_write_b64 v6, v[26:27] offset:16
    v_mov_b32 v8, 117264
    v_mov_b32 v9, s39
    ds_write_b32 v8, v9
L_sk0_31:
    s_mov_b32 s76, s39
    s_lshr_b32 s77, s39, 8
    s_lshr_b32 s78, s39, 16
    s_lshr_b32 s79, s39, 24
    v_mov_b32 v158, 0x0c0c0400
    v_mov_b32 v159, 0x04000c0c
    v_mov_b32 v157, 0xff
    v_and_b32 v44, 3, v0
    v_lshlrev_b32 v44, 3, v44
    v_lshrrev_b32 v156, v44, s39
    s_lshl_b32 s41, s36, 15
    s_lshl_b32 s42, s38, 8
    s_add_u32 s41, s41, s42
    s_add_u32 s41, s41, 65536
    v_lshl_add_u32 v160, v1, 4, s41
    v_lshl_add_u32 v160, v2, 13, v160
    v_add_u32 v161, 4096, v160
    s_lshl_b32 s41, s38, 7
    s_add_u32 s41, s41, 115968
    v_lshrrev_b32 v162, 3, v1
    v_lshlrev_b32 v162, 6, v162
    v_and_b32 v44, 3, v1
    v_lshl_add_u32 v162, v44, 4, v162
    v_bfe_u32 v44, v1, 2, 1
    v_lshl_add_u32 v162, v44, 3, v162
    v_add_u32 v162, s41, v162
    v_lshlrev_b32 v163, 4, v2
    v_add_u32 v163, 115968, v163
    s_lshl_b32 s41, s36, 11
    s_lshl_b32 s42, s43, 8
    s_add_u32 s41, s41, s42
    s_lshl_b32 s42, s38, 6
    s_add_u32 s41, s41, s42
    s_add_u32 s41, s41, 393216
    v_lshl_add_u32 v164, v1, 2, s41
    s_lshr_b32 s41, s38, 1
    s_lshl_b32 s41, s41, 6
    s_add_u32 s41, s41, 116992
    v_lshl_add_u32 v165, v2, 4, s41
    s_lshl_b32 s41, s36, 10
    s_add_u32 s41, s41, 327680
    v_lshl_add_u32 v166, v0, 4, s41
    v_and_b32 v167, 3, v0
    v_lshlrev_b32 v167, 6, v167
    v_lshrrev_b32 v44, 2, v0
    v_lshl_add_u32 v167, v44, 2, v167
    v_add_u32 v167, 116992, v167
    s_branch L_gc_bl
L_gc_L:
    s_barrier
    s_and_b32 s71, s38, 1
    s_cmp_ge_u32 s38, 6
    s_cbranch_scc1 L_gc_L67
    s_mov_b32 s48, s28
    s_and_b32 s49, s29, 0xffff
    s_mov_b32 s50, 3145728
    s_mov_b32 s51, 0x20000
    v_bfe_u32 v4, v0, 1, 1
    v_and_b32 v5, 1, v2
    v_xor_b32 v4, v4, v5
    v_and_b32 v5, 1, v0
    v_lshl_or_b32 v4, v4, 1, v5
    v_lshlrev_b32 v4, 4, v4
    v_lshrrev_b32 v5, 2, v0
    v_mul_u32_u24 v5, 6144, v5
    v_add_u32 v4, v4, v5
    s_mul_i32 s68, s71, 1572864
    s_lshl_b32 s41, s40, 6
    s_add_u32 s68, s68, s41
    s_add_u32 s68, s68, 2048
    s_lshl_b32 s70, s71, 14
    s_mov_b32 s60, s34
    s_and_b32 s61, s35, 0xffff
    s_mov_b32 s62, 2097152
    s_mov_b32 s63, 0x20000
    s_waitcnt lgkmcnt(0)
    s_add_u32 s39, s39, 0x01010101
    s_barrier
    s_add_u32 m0, s70, 16384
    s_nop 0
    buffer_load_dwordx4 v4, s[48:51], s68 offen nt lds
    s_add_u32 m0, s70, 17408
    s_add_u32 s68, s68, 98304
    buffer_load_dwordx4 v4, s[48:51], s68 offen nt lds
    s_add_u32 m0, s70, 18432
    s_add_u32 s68, s68, 98304
    buffer_load_dwordx4 v4, s[48:51], s68 offen nt lds
    s_add_u32 m0, s70, 19456
    s_add_u32 s68, s68, 98304
    buffer_load_dwordx4 v4, s[48:51], s68 offen nt lds
    s_add_u32 m0, s70, 20480
    s_add_u32 s68, s68, 98304
    buffer_load_dwordx4 v4, s[48:51], s68 offen nt lds
    s_add_u32 m0, s70, 21504
    s_add_u32 s68, s68, 98304
    buffer_load_dwordx4 v4, s[48:51], s68 offen nt lds
    s_add_u32 m0, s70, 22528
    s_add_u32 s68, s68, 98304
    buffer_load_dwordx4 v4, s[48:51], s68 offen nt lds
    s_add_u32 m0, s70, 23552
    s_add_u32 s68, s68, 98304
    buffer_load_dwordx4 v4, s[48:51], s68 offen nt lds
    s_add_u32 m0, s70, 24576
    s_add_u32 s68, s68, 98304
    buffer_load_dwordx4 v4, s[48:51], s68 offen nt lds
    s_add_u32 m0, s70, 25600
    s_add_u32 s68, s68, 98304
    buffer_load_dwordx4 v4, s[48:51], s68 offen nt lds
    s_add_u32 m0, s70, 26624
    s_add_u32 s68, s68, 98304
    buffer_load_dwordx4 v4, s[48:51], s68 offen nt lds
    s_add_u32 m0, s70, 27648
    s_add_u32 s68, s68, 98304
    buffer_load_dwordx4 v4, s[48:51], s68 offen nt lds
    s_add_u32 m0, s70, 28672
    s_add_u32 s68, s68, 98304
    buffer_load_dwordx4 v4, s[48:51], s68 offen nt lds
    s_add_u32 m0, s70, 29696
    s_add_u32 s68, s68, 98304
    buffer_load_dwordx4 v4, s[48:51], s68 offen nt lds
    s_add_u32 m0, s70, 30720
    s_add_u32 s68, s68, 98304
    buffer_load_dwordx4 v4, s[48:51], s68 offen nt lds
    s_add_u32 m0, s70, 31744
    s_add_u32 s68, s68, 98304
    buffer_load_dwordx4 v4, s[48:51], s68 offen nt lds
    s_lshl_b32 s41, s71, 2
    s_add_u32 s41, s41, 117280
    v_mov_b32 v22, s41
    v_mov_b32 v23, s39
    ds_write_b32 v22, v23
    s_mov_b32 s76, s39
    s_lshr_b32 s77, s39, 8
    s_lshr_b32 s78, s39, 16
    s_lshr_b32 s79, s39, 24
    v_mov_b32 v158, 0x0c0c0400
    v_mov_b32 v159, 0x04000c0c
    v_mov_b32 v157, 0xff
    v_and_b32 v44, 3, v0
    v_lshlrev_b32 v44, 3, v44
    v_lshrrev_b32 v156, v44, s39
    s_lshl_b32 s41, s36, 15
    s_lshl_b32 s42, s38, 8
    s_add_u32 s41, s41, s42
    s_add_u32 s41, s41, 65536
    v_lshl_add_u32 v160, v1, 4, s41
    v_lshl_add_u32 v160, v2, 13, v160
    v_add_u32 v161, 4096, v160
    s_lshl_b32 s41, s38, 7
    s_add_u32 s41, s41, 115968
    v_lshrrev_b32 v162, 3, v1
    v_lshlrev_b32 v162, 6, v162
    v_and_b32 v44, 3, v1
    v_lshl_add_u32 v162, v44, 4, v162
    v_bfe_u32 v44, v1, 2, 1
    v_lshl_add_u32 v162, v44, 3, v162
    v_add_u32 v162, s41, v162
    v_lshlrev_b32 v163, 4, v2
    v_add_u32 v163, 115968, v163
    s_lshl_b32 s41, s36, 11
    s_lshl_b32 s42, s43, 8
    s_add_u32 s41, s41, s42
    s_lshl_b32 s42, s38, 6
    s_add_u32 s41, s41, s42
    s_add_u32 s41, s41, 393216
    v_lshl_add_u32 v164, v1, 2, s41
    s_lshr_b32 s41, s38, 1
    s_lshl_b32 s41, s41, 6
    s_add_u32 s41, s41, 116992
    v_lshl_add_u32 v165, v2, 4, s41
    s_lshl_b32 s41, s36, 10
    s_add_u32 s41, s41, 327680
    v_lshl_add_u32 v166, v0, 4, s41
    v_and_b32 v167, 3, v0
    v_lshlrev_b32 v167, 6, v167
    v_lshrrev_b32 v44, 2, v0
    v_lshl_add_u32 v167, v44, 2, v167
    v_add_u32 v167, 116992, v167
    s_lshl_b32 s41, s71, 2
    s_add_u32 s41, s41, 117268
    v_mov_b32 v24, 117264
    s_waitcnt vmcnt(0)
    v_mov_b32 v22, s41
    v_mov_b32 v23, s39
    ds_write_b32 v22, v23
    s_mov_b32 s7, 0
L_poll_32:
    ds_read_b96 v[28:30], v24
    s_waitcnt lgkmcnt(0)
    v_xor_b32 v28, s39, v28
    v_xor_b32 v29, s39, v29
    v_xor_b32 v30, s39, v30
    v_or3_b32 v28, v28, v29, v30
    v_cmp_ne_u32 vcc, 0, v28
    s_cbranch_vccz L_ok_33
    s_add_u32 s7, s7, 1
    s_cmp_lt_u32 s7, 200000
    s_cbranch_scc1 L_poll_32
    s_branch L_end
L_ok_33:
    s_sub_u32 s42, s38, 4
    v_and_b32 v20, 1, v2
    v_xor_b32 v20, s42, v20
    v_lshlrev_b32 v20, 5, v20
    v_lshrrev_b32 v21, 2, v0
    v_lshl_add_u32 v20, v21, 6, v20
    v_and_b32 v21, 3, v0
    v_lshl_add_u32 v20, v21, 3, v20
    v_add_u32 v20, 16384, v20
    ds_read_b64_tr_b16 v[64:65], v20 offset:0
    ds_read_b64_tr_b16 v[66:67], v20 offset:1024
    ds_read_b64_tr_b16 v[68:69], v20 offset:2048
    ds_read_b64_tr_b16 v[70:71], v20 offset:3072
    ds_read_b64_tr_b16 v[72:73], v20 offset:4096
    ds_read_b64_tr_b16 v[74:75], v20 offset:5120
    ds_read_b64_tr_b16 v[76:77], v20 offset:6144
    ds_read_b64_tr_b16 v[78:79], v20 offset:7168
    ds_read_b64_tr_b16 v[80:81], v20 offset:8192
    ds_read_b64_tr_b16 v[82:83], v20 offset:9216
    ds_read_b64_tr_b16 v[84:85], v20 offset:10240
    ds_read_b64_tr_b16 v[86:87], v20 offset:11264
    ds_read_b64_tr_b16 v[88:89], v20 offset:12288
    ds_read_b64_tr_b16 v[90:91], v20 offset:13312
    ds_read_b64_tr_b16 v[92:93], v20 offset:14336
    ds_read_b64_tr_b16 v[94:95], v20 offset:15360
    ds_read_b64_tr_b16 v[96:97], v20 offset:16384
    ds_read_b64_tr_b16 v[98:99], v20 offset:17408
    ds_read_b64_tr_b16 v[100:101], v20 offset:18432
    ds_read_b64_tr_b16 v[102:103], v20 offset:19456
    ds_read_b64_tr_b16 v[104:105], v20 offset:20480
    ds_read_b64_tr_b16 v[106:107], v20 offset:21504
    ds_read_b64_tr_b16 v[108:109], v20 offset:22528
    ds_read_b64_tr_b16 v[110:111], v20 offset:23552
    ds_read_b64_tr_b16 v[112:113], v20 offset:24576
    ds_read_b64_tr_b16 v[114:115], v20 offset:25600
    ds_read_b64_tr_b16 v[116:117], v20 offset:26624
    ds_read_b64_tr_b16 v[118:119], v20 offset:27648
    ds_read_b64_tr_b16 v[120:121], v20 offset:28672
    ds_read_b64_tr_b16 v[122:123], v20 offset:29696
    ds_read_b64_tr_b16 v[124:125], v20 offset:30720
    ds_read_b64_tr_b16 v[126:127], v20 offset:31744
    v_lshlrev_b32 v7, 4, v2
    v_add_u32 v7, 114944, v7
    s_lshl_b32 s41, s40, 7
    s_lshl_b32 s42, s42, 6
    s_add_u32 s41, s41, s42
    s_add_u32 s41, s41, 8192
    v_lshl_add_u32 v21, v1, 2, s41
    s_mov_b32 s82, 0xaaaaaaaa
    s_mov_b32 s83, 0xaaaaaaaa
    s_waitcnt lgkmcnt(0)
    ds_read_b128 v[24:27], v7 offset:0
    ds_read_b128 v[28:31], v7 offset:64
    ds_read_b128 v[32:35], v7 offset:128
    ds_read_b128 v[36:39], v7 offset:192
    ds_read_b128 v[40:43], v7 offset:256
    ds_read_b128 v[44:47], v7 offset:320
    ds_read_b128 v[48:51], v7 offset:384
    ds_read_b128 v[52:55], v7 offset:448
    s_waitcnt lgkmcnt(7)
    v_mfma_f32_16x16x32_bf16 v[56:59], v[24:27], v[64:67], 0
    ds_read_b128 v[24:27], v7 offset:512
    s_waitcnt lgkmcnt(7)
    v_mfma_f32_16x16x32_bf16 v[56:59], v[28:31], v[68:71], v[56:59]
    ds_read_b128 v[28:31], v7 offset:576
    s_waitcnt lgkmcnt(7)
    v_mfma_f32_16x16x32_bf16 v[56:59], v[32:35], v[72:75], v[56:59]
    ds_read_b128 v[32:35], v7 offset:640
    s_waitcnt lgkmcnt(7)
    v_mfma_f32_16x16x32_bf16 v[56:59], v[36:39], v[76:79], v[56:59]
    ds_read_b128 v[36:39], v7 offset:704
    s_waitcnt lgkmcnt(7)
    v_mfma_f32_16x16x32_bf16 v[56:59], v[40:43], v[80:83], v[56:59]
    ds_read_b128 v[40:43], v7 offset:768
    s_waitcnt lgkmcnt(7)
    v_mfma_f32_16x16x32_bf16 v[56:59], v[44:47], v[84:87], v[56:59]
    ds_read_b128 v[44:47], v7 offset:832
    s_waitcnt lgkmcnt(7)
    v_mfma_f32_16x16x32_bf16 v[56:59], v[48:51], v[88:91], v[56:59]
    ds_read_b128 v[48:51], v7 offset:896
    s_waitcnt lgkmcnt(7)
    v_mfma_f32_16x16x32_bf16 v[56:59], v[52:55], v[92:95], v[56:59]
    ds_read_b128 v[52:55], v7 offset:960
    s_waitcnt lgkmcnt(7)
    v_mfma_f32_16x16x32_bf16 v[56:59], v[24:27], v[96:99], v[56:59]
    s_waitcnt lgkmcnt(6)
    v_mfma_f32_16x16x32_bf16 v[56:59], v[28:31], v[100:103], v[56:59]
    s_waitcnt lgkmcnt(5)
    v_mfma_f32_16x16x32_bf16 v[56:59], v[32:35], v[104:107], v[56:59]
    s_waitcnt lgkmcnt(4)
    v_mfma_f32_16x16x32_bf16 v[56:59], v[36:39], v[108:111], v[56:59]
    s_waitcnt lgkmcnt(3)
    v_mfma_f32_16x16x32_bf16 v[56:59], v[40:43], v[112:115], v[56:59]
    s_waitcnt lgkmcnt(2)
    v_mfma_f32_16x16x32_bf16 v[56:59], v[44:47], v[116:119], v[56:59]
    s_waitcnt lgkmcnt(1)
    v_mfma_f32_16x16x32_bf16 v[56:59], v[48:51], v[120:123], v[56:59]
    s_waitcnt lgkmcnt(0)
    v_mfma_f32_16x16x32_bf16 v[56:59], v[52:55], v[124:127], v[56:59]
    s_mov_b64 exec, 0xffff
    s_nop 6
    v_mov_b32_dpp v61, v56 quad_perm:[1,0,3,2] row_mask:0xf bank_mask:0xf
    v_cvt_pk_bf16_f32 v60, v56, v61
    v_mov_b32 v61, s39
    v_cndmask_b32 v60, v60, v61, s[82:83]
    buffer_store_dword v60, v21, s[60:63], 0 offen sc1
    s_mov_b64 exec, -1
    s_branch L_gc_bl
L_gc_L67:
    s_mov_b32 s56, s16
    s_and_b32 s57, s17, 0xffff
    s_mov_b32 s58, 4194304
    s_mov_b32 s59, 0x20000
    v_bfe_u32 v8, v0, 1, 2
    v_and_b32 v9, 3, v2
    v_xor_b32 v8, v8, v9
    v_and_b32 v9, 1, v0
    v_lshl_or_b32 v8, v8, 1, v9
    v_lshlrev_b32 v8, 4, v8
    v_lshrrev_b32 v7, 3, v0
    v_lshl_add_u32 v7, v7, 10, v8
    s_lshl_b32 s68, s36, 19
    s_lshl_b32 s41, s71, 18
    s_add_u32 s68, s68, s41
    s_lshl_b32 s41, s43, 7
    s_add_u32 s68, s68, s41
    s_lshl_b32 s70, s71, 15
    s_mov_b32 s60, s34
    s_and_b32 s61, s35, 0xffff
    s_mov_b32 s62, 2097152
    s_mov_b32 s63, 0x20000
    s_waitcnt lgkmcnt(0)
    s_add_u32 s39, s39, 0x01010101
    s_barrier
    v_mov_b32 v24, 117280
    s_mov_b32 s7, 0
L_poll_34:
    ds_read_b64 v[28:29], v24
    s_waitcnt lgkmcnt(0)
    v_xor_b32 v28, s39, v28
    v_xor_b32 v29, s39, v29
    v_or_b32 v28, v28, v29
    v_cmp_ne_u32 vcc, 0, v28
    s_cbranch_vccz L_ok_35
    s_add_u32 s7, s7, 1
    s_cmp_lt_u32 s7, 200000
    s_cbranch_scc1 L_poll_34
    s_branch L_end
L_ok_35:
    s_add_u32 m0, s70, 49152
    s_nop 0
    buffer_load_dwordx4 v7, s[56:59], s68 offen nt lds
    s_add_u32 m0, s70, 50176
    s_add_u32 s68, s68, 8192
    buffer_load_dwordx4 v7, s[56:59], s68 offen nt lds
    s_add_u32 m0, s70, 51200
    s_add_u32 s68, s68, 8192
    buffer_load_dwordx4 v7, s[56:59], s68 offen nt lds
    s_add_u32 m0, s70, 52224
    s_add_u32 s68, s68, 8192
    buffer_load_dwordx4 v7, s[56:59], s68 offen nt lds
    s_add_u32 m0, s70, 53248
    s_add_u32 s68, s68, 8192
    buffer_load_dwordx4 v7, s[56:59], s68 offen nt lds
    s_add_u32 m0, s70, 54272
    s_add_u32 s68, s68, 8192
    buffer_load_dwordx4 v7, s[56:59], s68 offen nt lds
    s_add_u32 m0, s70, 55296
    s_add_u32 s68, s68, 8192
    buffer_load_dwordx4 v7, s[56:59], s68 offen nt lds
    s_add_u32 m0, s70, 56320
    s_add_u32 s68, s68, 8192
    buffer_load_dwordx4 v7, s[56:59], s68 offen nt lds
    s_add_u32 m0, s70, 57344
    s_add_u32 s68, s68, 8192
    buffer_load_dwordx4 v7, s[56:59], s68 offen nt lds
    s_add_u32 m0, s70, 58368
    s_add_u32 s68, s68, 8192
    buffer_load_dwordx4 v7, s[56:59], s68 offen nt lds
    s_add_u32 m0, s70, 59392
    s_add_u32 s68, s68, 8192
    buffer_load_dwordx4 v7, s[56:59], s68 offen nt lds
    s_add_u32 m0, s70, 60416
    s_add_u32 s68, s68, 8192
    buffer_load_dwordx4 v7, s[56:59], s68 offen nt lds
    s_add_u32 m0, s70, 61440
    s_add_u32 s68, s68, 8192
    buffer_load_dwordx4 v7, s[56:59], s68 offen nt lds
    s_add_u32 m0, s70, 62464
    s_add_u32 s68, s68, 8192
    buffer_load_dwordx4 v7, s[56:59], s68 offen nt lds
    s_add_u32 m0, s70, 63488
    s_add_u32 s68, s68, 8192
    buffer_load_dwordx4 v7, s[56:59], s68 offen nt lds
    s_add_u32 m0, s70, 64512
    s_add_u32 s68, s68, 8192
    buffer_load_dwordx4 v7, s[56:59], s68 offen nt lds
    s_add_u32 m0, s70, 65536
    s_add_u32 s68, s68, 8192
    buffer_load_dwordx4 v7, s[56:59], s68 offen nt lds
    s_add_u32 m0, s70, 66560
    s_add_u32 s68, s68, 8192
    buffer_load_dwordx4 v7, s[56:59], s68 offen nt lds
    s_add_u32 m0, s70, 67584
    s_add_u32 s68, s68, 8192
    buffer_load_dwordx4 v7, s[56:59], s68 offen nt lds
    s_add_u32 m0, s70, 68608
    s_add_u32 s68, s68, 8192
    buffer_load_dwordx4 v7, s[56:59], s68 offen nt lds
    s_add_u32 m0, s70, 69632
    s_add_u32 s68, s68, 8192
    buffer_load_dwordx4 v7, s[56:59], s68 offen nt lds
    s_add_u32 m0, s70, 70656
    s_add_u32 s68, s68, 8192
    buffer_load_dwordx4 v7, s[56:59], s68 offen nt lds
    s_add_u32 m0, s70, 71680
    s_add_u32 s68, s68, 8192
    buffer_load_dwordx4 v7, s[56:59], s68 offen nt lds
    s_add_u32 m0, s70, 72704
    s_add_u32 s68, s68, 8192
    buffer_load_dwordx4 v7, s[56:59], s68 offen nt lds
    s_add_u32 m0, s70, 73728
    s_add_u32 s68, s68, 8192
    buffer_load_dwordx4 v7, s[56:59], s68 offen nt lds
    s_add_u32 m0, s70, 74752
    s_add_u32 s68, s68, 8192
    buffer_load_dwordx4 v7, s[56:59], s68 offen nt lds
    s_add_u32 m0, s70, 75776
    s_add_u32 s68, s68, 8192
    buffer_load_dwordx4 v7, s[56:59], s68 offen nt lds
    s_add_u32 m0, s70, 76800
    s_add_u32 s68, s68, 8192
    buffer_load_dwordx4 v7, s[56:59], s68 offen nt lds
    s_add_u32 m0, s70, 77824
    s_add_u32 s68, s68, 8192
    buffer_load_dwordx4 v7, s[56:59], s68 offen nt lds
    s_add_u32 m0, s70, 78848
    s_add_u32 s68, s68, 8192
    buffer_load_dwordx4 v7, s[56:59], s68 offen nt lds
    s_add_u32 m0, s70, 79872
    s_add_u32 s68, s68, 8192
    buffer_load_dwordx4 v7, s[56:59], s68 offen nt lds
    s_add_u32 m0, s70, 80896
    s_add_u32 s68, s68, 8192
    buffer_load_dwordx4 v7, s[56:59], s68 offen nt lds
    s_mov_b32 s76, s39
    s_lshr_b32 s77, s39, 8
    s_lshr_b32 s78, s39, 16
    s_lshr_b32 s79, s39, 24
    v_mov_b32 v158, 0x0c0c0400
    v_mov_b32 v159, 0x04000c0c
    v_mov_b32 v157, 0xff
    v_and_b32 v44, 3, v0
    v_lshlrev_b32 v44, 3, v44
    v_lshrrev_b32 v156, v44, s39
    s_lshl_b32 s41, s36, 15
    s_lshl_b32 s42, s38, 8
    s_add_u32 s41, s41, s42
    s_add_u32 s41, s41, 65536
    v_lshl_add_u32 v160, v1, 4, s41
    v_lshl_add_u32 v160, v2, 13, v160
    v_add_u32 v161, 4096, v160
    s_lshl_b32 s41, s38, 7
    s_add_u32 s41, s41, 115968
    v_lshrrev_b32 v162, 3, v1
    v_lshlrev_b32 v162, 6, v162
    v_and_b32 v44, 3, v1
    v_lshl_add_u32 v162, v44, 4, v162
    v_bfe_u32 v44, v1, 2, 1
    v_lshl_add_u32 v162, v44, 3, v162
    v_add_u32 v162, s41, v162
    v_lshlrev_b32 v163, 4, v2
    v_add_u32 v163, 115968, v163
    s_lshl_b32 s41, s36, 11
    s_lshl_b32 s42, s43, 8
    s_add_u32 s41, s41, s42
    s_lshl_b32 s42, s38, 6
    s_add_u32 s41, s41, s42
    s_add_u32 s41, s41, 393216
    v_lshl_add_u32 v164, v1, 2, s41
    s_lshr_b32 s41, s38, 1
    s_lshl_b32 s41, s41, 6
    s_add_u32 s41, s41, 116992
    v_lshl_add_u32 v165, v2, 4, s41
    s_lshl_b32 s41, s36, 10
    s_add_u32 s41, s41, 327680
    v_lshl_add_u32 v166, v0, 4, s41
    v_and_b32 v167, 3, v0
    v_lshlrev_b32 v167, 6, v167
    v_lshrrev_b32 v44, 2, v0
    v_lshl_add_u32 v167, v44, 2, v167
    v_add_u32 v167, 116992, v167
L_gc_bl:
    s_waitcnt vmcnt(0) lgkmcnt(0)
    s_barrier
    s_cmp_lt_u32 s38, 4
    s_cbranch_scc0 L_wpre_36
    v_bfe_u32 v44, v0, 3, 2
    v_xor_b32 v44, s38, v44
    v_lshrrev_b32 v45, 2, v0
    v_lshlrev_b32 v45, 7, v45
    v_lshl_add_u32 v45, v44, 5, v45
    v_and_b32 v44, 3, v0
    v_lshl_add_u32 v20, v44, 3, v45
    v_add_u32 v20, 49152, v20
    ds_read_b64_tr_b16 v[64:65], v20 offset:0
    ds_read_b64_tr_b16 v[66:67], v20 offset:2048
    ds_read_b64_tr_b16 v[68:69], v20 offset:4096
    ds_read_b64_tr_b16 v[70:71], v20 offset:6144
    ds_read_b64_tr_b16 v[72:73], v20 offset:8192
    ds_read_b64_tr_b16 v[74:75], v20 offset:10240
    ds_read_b64_tr_b16 v[76:77], v20 offset:12288
    ds_read_b64_tr_b16 v[78:79], v20 offset:14336
    ds_read_b64_tr_b16 v[80:81], v20 offset:16384
    ds_read_b64_tr_b16 v[82:83], v20 offset:18432
    ds_read_b64_tr_b16 v[84:85], v20 offset:20480
    ds_read_b64_tr_b16 v[86:87], v20 offset:22528
    ds_read_b64_tr_b16 v[88:89], v20 offset:24576
    ds_read_b64_tr_b16 v[90:91], v20 offset:26624
    ds_read_b64_tr_b16 v[92:93], v20 offset:28672
    ds_read_b64_tr_b16 v[94:95], v20 offset:30720
    ds_read_b64_tr_b16 v[96:97], v20 offset:32768
    ds_read_b64_tr_b16 v[98:99], v20 offset:34816
    ds_read_b64_tr_b16 v[100:101], v20 offset:36864
    ds_read_b64_tr_b16 v[102:103], v20 offset:38912
    ds_read_b64_tr_b16 v[104:105], v20 offset:40960
    ds_read_b64_tr_b16 v[106:107], v20 offset:43008
    ds_read_b64_tr_b16 v[108:109], v20 offset:45056
    ds_read_b64_tr_b16 v[110:111], v20 offset:47104
    ds_read_b64_tr_b16 v[112:113], v20 offset:49152
    ds_read_b64_tr_b16 v[114:115], v20 offset:51200
    ds_read_b64_tr_b16 v[116:117], v20 offset:53248
    ds_read_b64_tr_b16 v[118:119], v20 offset:55296
    ds_read_b64_tr_b16 v[120:121], v20 offset:57344
    ds_read_b64_tr_b16 v[122:123], v20 offset:59392
    ds_read_b64_tr_b16 v[124:125], v20 offset:61440
    ds_read_b64_tr_b16 v[126:127], v20 offset:63488
L_wpre_36:
    s_mov_b32 s68, 0x3fb8aa3b
    s_mov_b32 s69, 524288
    s_cmp_eq_u32 s38, 4
    s_cbranch_scc0 L_sent_37
    buffer_load_dwordx4 v[12:15], v160, s[60:63], s69 offen sc1
    buffer_load_dwordx4 v[16:19], v160, s[60:63], s69 offen offset:2048 sc1
    buffer_load_dwordx4 v[24:27], v161, s[60:63], s69 offen sc1
    buffer_load_dwordx4 v[28:31], v161, s[60:63], s69 offen offset:2048 sc1
    s_mov_b32 s7, 0
L_poll_38:
    s_and_b32 s41, s7, 7
    s_cmp_eq_u32 s41, 7
    s_cselect_b32 s41, 0, s69
    buffer_load_dwordx4 v[32:35], v166, s[60:63], s41 offen sc1
    s_waitcnt vmcnt(0)
    v_perm_b32 v49, v33, v32, v158
    v_perm_b32 v50, v35, v34, v159
    v_bitop3_b32 v48, v49, v50, s39 bitop3:0x56
    v_cmp_ne_u32 vcc, 0, v48
    s_cbranch_vccz L_ok_39
    s_add_u32 s7, s7, 1
    s_cmp_lt_u32 s7, 200000
    s_cbranch_scc1 L_poll_38
    s_branch L_end
L_ok_39:
    buffer_load_dwordx4 v[12:15], v160, s[60:63], s69 offen sc1
    buffer_load_dwordx4 v[16:19], v160, s[60:63], s69 offen offset:2048 sc1
    buffer_load_dwordx4 v[24:27], v161, s[60:63], s69 offen sc1
    buffer_load_dwordx4 v[28:31], v161, s[60:63], s69 offen offset:2048 sc1
    v_and_b32 v36, 0xffffff00, v32
    v_and_b32 v37, 0xffffff00, v33
    v_mov_b32 v38, v36
    s_nop 1
    v_max_f32_dpp v38, v38, v38 row_ror:4 row_mask:0xf bank_mask:0xf
    s_nop 1
    v_max_f32_dpp v38, v38, v38 row_ror:8 row_mask:0xf bank_mask:0xf
    v_mov_b32 v39, v38
    s_nop 1
    v_permlane16_swap_b32 v38, v39
    v_max_f32 v38, v38, v39
    v_mov_b32 v39, v38
    s_nop 1
    v_permlane32_swap_b32 v38, v39
    v_max_f32 v38, v38, v39
    v_sub_f32 v36, v36, v38
    v_mul_f32 v36, s68, v36
    v_exp_f32 v36, v36
    s_nop 0
    v_mul_f32 v37, v36, v37
    s_nop 1
    v_add_f32_dpp v37, v37, v37 row_ror:4 row_mask:0xf bank_mask:0xf
    s_nop 1
    v_add_f32_dpp v37, v37, v37 row_ror:8 row_mask:0xf bank_mask:0xf
    v_mov_b32 v39, v37
    s_nop 1
    v_permlane16_swap_b32 v37, v39
    v_add_f32 v37, v37, v39
    v_mov_b32 v39, v37
    s_nop 1
    v_permlane32_swap_b32 v37, v39
    v_add_f32 v37, v37, v39
    v_rcp_f32 v37, v37
    s_nop 0
    v_mul_f32 v36, v36, v37
    ds_write_b32 v167, v36
    v_mov_b32 v44, 117288
    v_mov_b32 v45, s39
    ds_write_b32 v44, v45
    s_waitcnt vmcnt(0)
    v_perm_b32 v49, v13, v12, v158
    v_perm_b32 v50, v15, v14, v159
    v_bitop3_b32 v48, v49, v50, s39 bitop3:0x56
    v_perm_b32 v49, v17, v16, v158
    v_perm_b32 v50, v19, v18, v159
    v_bitop3_b32 v49, v49, v50, s39 bitop3:0x56
    v_or_b32 v48, v48, v49
    v_perm_b32 v49, v25, v24, v158
    v_perm_b32 v50, v27, v26, v159
    v_bitop3_b32 v49, v49, v50, s39 bitop3:0x56
    v_or_b32 v48, v48, v49
    v_perm_b32 v49, v29, v28, v158
    v_perm_b32 v50, v31, v30, v159
    v_bitop3_b32 v49, v49, v50, s39 bitop3:0x56
    v_or_b32 v48, v48, v49
    v_cmp_ne_u32 vcc, 0, v48
    s_cbranch_vccz L_odone_40
L_sent_37:
    s_mov_b32 s7, 0
L_poll_41:
    s_and_b32 s41, s7, 7
    s_cmp_eq_u32 s41, 7
    s_cselect_b32 s41, 0, s69
    buffer_load_dwordx4 v[12:15], v160, s[60:63], s41 offen sc1
    buffer_load_dwordx4 v[16:19], v160, s[60:63], s41 offen offset:2048 sc1
    buffer_load_dwordx4 v[24:27], v161, s[60:63], s41 offen sc1
    buffer_load_dwordx4 v[28:31], v161, s[60:63], s41 offen offset:2048 sc1
    s_waitcnt vmcnt(0)
    v_perm_b32 v49, v13, v12, v158
    v_perm_b32 v50, v15, v14, v159
    v_bitop3_b32 v48, v49, v50, s39 bitop3:0x56
    v_perm_b32 v49, v17, v16, v158
    v_perm_b32 v50, v19, v18, v159
    v_bitop3_b32 v49, v49, v50, s39 bitop3:0x56
    v_or_b32 v48, v48, v49
    v_perm_b32 v49, v25, v24, v158
    v_perm_b32 v50, v27, v26, v159
    v_bitop3_b32 v49, v49, v50, s39 bitop3:0x56
    v_or_b32 v48, v48, v49
    v_perm_b32 v49, v29, v28, v158
    v_perm_b32 v50, v31, v30, v159
    v_bitop3_b32 v49, v49, v50, s39 bitop3:0x56
    v_or_b32 v48, v48, v49
    v_cmp_ne_u32 vcc, 0, v48
    s_cbranch_vccz L_ok_42
    s_add_u32 s7, s7, 1
    s_cmp_lt_u32 s7, 200000
    s_cbranch_scc1 L_poll_41
    s_branch L_end
L_ok_42:
L_odone_40:
    v_and_b32 v12, 0xffffff00, v12
    v_and_b32 v13, 0xffffff00, v13
    v_and_b32 v14, 0xffffff00, v14
    v_and_b32 v15, 0xffffff00, v15
    v_and_b32 v16, 0xffffff00, v16
    v_and_b32 v17, 0xffffff00, v17
    v_and_b32 v18, 0xffffff00, v18
    v_and_b32 v19, 0xffffff00, v19
    v_and_b32 v24, 0xffffff00, v24
    v_and_b32 v25, 0xffffff00, v25
    v_and_b32 v26, 0xffffff00, v26
    v_and_b32 v27, 0xffffff00, v27
    v_and_b32 v28, 0xffffff00, v28
    v_and_b32 v29, 0xffffff00, v29
    v_and_b32 v30, 0xffffff00, v30
    v_and_b32 v31, 0xffffff00, v31
    s_waitcnt lgkmcnt(0)
    s_barrier
    ds_read_b128 v[32:35], v165
    s_waitcnt lgkmcnt(0)
    v_mul_f32 v48, v32, v12
    v_mul_f32 v49, v32, v13
    v_mul_f32 v50, v32, v14
    v_mul_f32 v51, v32, v15
    v_fmac_f32 v48, v33, v16
    v_fmac_f32 v49, v33, v17
    v_fmac_f32 v50, v33, v18
    v_fmac_f32 v51, v33, v19
    v_fmac_f32 v48, v34, v24
    v_fmac_f32 v49, v34, v25
    v_fmac_f32 v50, v34, v26
    v_fmac_f32 v51, v34, v27
    v_fmac_f32 v48, v35, v28
    v_fmac_f32 v49, v35, v29
    v_fmac_f32 v50, v35, v30
    v_fmac_f32 v51, v35, v31
    v_mov_b32 v53, v48
    v_mov_b32 v54, v49
    v_mov_b32 v55, v50
    v_mov_b32 v56, v51
    v_permlane16_swap_b32 v48, v53
    v_permlane16_swap_b32 v49, v54
    v_permlane16_swap_b32 v50, v55
    v_permlane16_swap_b32 v51, v56
    v_add_f32 v48, v48, v53
    v_add_f32 v49, v49, v54
    v_add_f32 v50, v50, v55
    v_add_f32 v51, v51, v56
    v_mov_b32 v53, v48
    v_mov_b32 v54, v49
    v_mov_b32 v55, v50
    v_mov_b32 v56, v51
    v_permlane32_swap_b32 v48, v53
    v_permlane32_swap_b32 v49, v54
    v_permlane32_swap_b32 v50, v55
    v_permlane32_swap_b32 v51, v56
    v_add_f32 v48, v48, v53
    v_add_f32 v49, v49, v54
    v_add_f32 v50, v50, v55
    v_add_f32 v51, v51, v56
    v_cvt_pk_bf16_f32 v48, v48, v49
    v_cvt_pk_bf16_f32 v49, v50, v51
    ds_write_b64 v162, v[48:49]
    s_waitcnt lgkmcnt(0)
    s_barrier
    s_cmp_lt_u32 s38, 4
    s_cbranch_scc0 L_omm_43
    ds_read_b128 v[24:27], v163 offset:0
    ds_read_b128 v[28:31], v163 offset:64
    ds_read_b128 v[32:35], v163 offset:128
    ds_read_b128 v[36:39], v163 offset:192
    ds_read_b128 v[40:43], v163 offset:256
    ds_read_b128 v[44:47], v163 offset:320
    ds_read_b128 v[48:51], v163 offset:384
    ds_read_b128 v[52:55], v163 offset:448
    s_waitcnt lgkmcnt(7)
    v_mfma_f32_16x16x32_bf16 v[56:59], v[24:27], v[64:67], 0
    ds_read_b128 v[24:27], v163 offset:512
    s_waitcnt lgkmcnt(7)
    v_mfma_f32_16x16x32_bf16 v[56:59], v[28:31], v[68:71], v[56:59]
    ds_read_b128 v[28:31], v163 offset:576
    s_waitcnt lgkmcnt(7)
    v_mfma_f32_16x16x32_bf16 v[56:59], v[32:35], v[72:75], v[56:59]
    ds_read_b128 v[32:35], v163 offset:640
    s_waitcnt lgkmcnt(7)
    v_mfma_f32_16x16x32_bf16 v[56:59], v[36:39], v[76:79], v[56:59]
    ds_read_b128 v[36:39], v163 offset:704
    s_waitcnt lgkmcnt(7)
    v_mfma_f32_16x16x32_bf16 v[56:59], v[40:43], v[80:83], v[56:59]
    ds_read_b128 v[40:43], v163 offset:768
    s_waitcnt lgkmcnt(7)
    v_mfma_f32_16x16x32_bf16 v[56:59], v[44:47], v[84:87], v[56:59]
    ds_read_b128 v[44:47], v163 offset:832
    s_waitcnt lgkmcnt(7)
    v_mfma_f32_16x16x32_bf16 v[56:59], v[48:51], v[88:91], v[56:59]
    ds_read_b128 v[48:51], v163 offset:896
    s_waitcnt lgkmcnt(7)
    v_mfma_f32_16x16x32_bf16 v[56:59], v[52:55], v[92:95], v[56:59]
    ds_read_b128 v[52:55], v163 offset:960
    s_waitcnt lgkmcnt(7)
    v_mfma_f32_16x16x32_bf16 v[56:59], v[24:27], v[96:99], v[56:59]
    s_waitcnt lgkmcnt(6)
    v_mfma_f32_16x16x32_bf16 v[56:59], v[28:31], v[100:103], v[56:59]
    s_waitcnt lgkmcnt(5)
    v_mfma_f32_16x16x32_bf16 v[56:59], v[32:35], v[104:107], v[56:59]
    s_waitcnt lgkmcnt(4)
    v_mfma_f32_16x16x32_bf16 v[56:59], v[36:39], v[108:111], v[56:59]
    s_waitcnt lgkmcnt(3)
    v_mfma_f32_16x16x32_bf16 v[56:59], v[40:43], v[112:115], v[56:59]
    s_waitcnt lgkmcnt(2)
    v_mfma_f32_16x16x32_bf16 v[56:59], v[44:47], v[116:119], v[56:59]
    s_waitcnt lgkmcnt(1)
    v_mfma_f32_16x16x32_bf16 v[56:59], v[48:51], v[120:123], v[56:59]
    s_waitcnt lgkmcnt(0)
    v_mfma_f32_16x16x32_bf16 v[56:59], v[52:55], v[124:127], v[56:59]
    s_mov_b64 exec, 0xffff
    s_nop 6
    v_bfi_b32 v56, v157, v156, v56
    buffer_store_dword v56, v164, s[60:63], 0 offen sc1
    s_mov_b64 exec, -1
    s_branch L_gc_done
L_omm_43:
L_fin:
    s_cmp_ge_u32 s38, 6
    s_cbranch_scc1 L_gc_done
    s_mov_b32 s52, s30
    s_and_b32 s53, s31, 0xffff
    s_mov_b32 s54, 1024
    s_mov_b32 s55, 0x20000
    s_mov_b32 s64, s8
    s_and_b32 s65, s9, 0xffff
    s_mov_b32 s66, 1024
    s_mov_b32 s67, 0x20000
    v_mov_b32 v8, 0x0c0c0400
    v_mov_b32 v9, 0x04000c0c
    s_lshl_b32 s68, s40, 3
    s_sub_u32 s41, s38, 4
    s_lshl_b32 s41, s41, 2
    s_add_u32 s68, s68, s41
    s_lshl_b32 s69, s68, 2
    s_lshl_b32 s70, s68, 1
    v_mov_b32 v20, s70
    buffer_load_dwordx2 v[22:23], v20, s[64:67], 0 offen
    s_add_u32 s41, s69, 8192
    v_mov_b32 v5, s41
    v_add_u32 v6, 6144, v5
    v_and_b32 v7, 7, v0
    v_lshlrev_b32 v7, 11, v7
    s_add_u32 s41, s69, 393216
    v_add_u32 v7, s41, v7
    s_mov_b32 s7, 0
L_poll_44:
    buffer_load_dwordx4 v[12:15], v5, s[60:63], 0 offen sc1
    buffer_load_dwordx4 v[16:19], v6, s[60:63], 0 offen sc1
    buffer_load_dwordx4 v[24:27], v7, s[60:63], 0 offen sc1
    s_waitcnt vmcnt(0)
    v_perm_b32 v49, v25, v24, v8
    v_perm_b32 v50, v27, v26, v9
    v_bitop3_b32 v48, v49, v50, s39 bitop3:0x56
    v_xor_b32 v49, s39, v13
    v_or_b32 v48, v48, v49
    v_xor_b32 v49, s39, v15
    v_or_b32 v48, v48, v49
    v_xor_b32 v49, s39, v17
    v_or_b32 v48, v48, v49
    v_xor_b32 v49, s39, v19
    v_or_b32 v48, v48, v49
    v_cmp_ne_u32 vcc, 0, v48
    s_cbranch_vccz L_ok_45
    s_add_u32 s7, s7, 1
    s_cmp_lt_u32 s7, 200000
    s_cbranch_scc1 L_poll_44
    s_branch L_end
L_ok_45:
    v_and_b32 v24, 0xffffff00, v24
    v_and_b32 v25, 0xffffff00, v25
    v_and_b32 v26, 0xffffff00, v26
    v_and_b32 v27, 0xffffff00, v27
    s_nop 1
    v_mov_b32_dpp v28, v24 row_ror:12 row_mask:0xf bank_mask:0xf
    v_mov_b32_dpp v29, v25 row_ror:12 row_mask:0xf bank_mask:0xf
    v_mov_b32_dpp v30, v26 row_ror:12 row_mask:0xf bank_mask:0xf
    v_mov_b32_dpp v31, v27 row_ror:12 row_mask:0xf bank_mask:0xf
    v_add_f32 v24, v24, v28
    v_add_f32 v25, v25, v29
    v_add_f32 v26, v26, v30
    v_add_f32 v27, v27, v31
    s_nop 1
    v_add_f32_dpp v24, v24, v24 quad_perm:[1,0,3,2] row_mask:0xf bank_mask:0xf
    v_add_f32_dpp v25, v25, v25 quad_perm:[1,0,3,2] row_mask:0xf bank_mask:0xf
    v_add_f32_dpp v26, v26, v26 quad_perm:[1,0,3,2] row_mask:0xf bank_mask:0xf
    v_add_f32_dpp v27, v27, v27 quad_perm:[1,0,3,2] row_mask:0xf bank_mask:0xf
    s_nop 1
    v_add_f32_dpp v24, v24, v24 quad_perm:[2,3,0,1] row_mask:0xf bank_mask:0xf
    v_add_f32_dpp v25, v25, v25 quad_perm:[2,3,0,1] row_mask:0xf bank_mask:0xf
    v_add_f32_dpp v26, v26, v26 quad_perm:[2,3,0,1] row_mask:0xf bank_mask:0xf
    v_add_f32_dpp v27, v27, v27 quad_perm:[2,3,0,1] row_mask:0xf bank_mask:0xf
    v_lshlrev_b32 v28, 16, v12
    v_and_b32 v29, 0xffff0000, v12
    v_lshlrev_b32 v30, 16, v14
    v_and_b32 v31, 0xffff0000, v14
    v_lshlrev_b32 v32, 16, v16
    v_and_b32 v33, 0xffff0000, v16
    v_lshlrev_b32 v34, 16, v18
    v_and_b32 v35, 0xffff0000, v18
    v_lshlrev_b32 v36, 16, v22
    v_and_b32 v37, 0xffff0000, v22
    v_lshlrev_b32 v38, 16, v23
    v_and_b32 v39, 0xffff0000, v23
    v_fma_f32 v24, v28, v24, v36
    v_fma_f32 v25, v29, v25, v37
    v_fma_f32 v26, v30, v26, v38
    v_fma_f32 v27, v31, v27, v39
    v_cvt_pk_bf16_f32 v48, v24, v25
    v_lshlrev_b32 v24, 16, v48
    v_and_b32 v25, 0xffff0000, v48
    v_cvt_pk_bf16_f32 v49, v26, v27
    v_lshlrev_b32 v26, 16, v49
    v_and_b32 v27, 0xffff0000, v49
    v_min_u32 v7, 55, v0
    v_lshlrev_b32 v7, 11, v7
    s_add_u32 s41, s69, 458752
    v_add_u32 v7, s41, v7
    v_cmp_gt_u32 s[80:81], 56, v0
    s_mov_b32 s7, 0
L_poll_46:
    buffer_load_dwordx4 v[40:43], v7, s[60:63], 0 offen sc1
    s_waitcnt vmcnt(0)
    v_perm_b32 v49, v41, v40, v8
    v_perm_b32 v50, v43, v42, v9
    v_bitop3_b32 v48, v49, v50, s39 bitop3:0x56
    v_cmp_ne_u32 vcc, 0, v48
    s_cbranch_vccz L_ok_47
    s_add_u32 s7, s7, 1
    s_cmp_lt_u32 s7, 200000
    s_cbranch_scc1 L_poll_46
    s_branch L_end
L_ok_47:
    v_and_b32 v40, 0xffffff00, v40
    v_and_b32 v41, 0xffffff00, v41
    v_and_b32 v42, 0xffffff00, v42
    v_and_b32 v43, 0xffffff00, v43
    v_cndmask_b32 v40, 0, v40, s[80:81]
    v_cndmask_b32 v41, 0, v41, s[80:81]
    v_cndmask_b32 v42, 0, v42, s[80:81]
    v_cndmask_b32 v43, 0, v43, s[80:81]
    v_add_f32_dpp v40, v40, v40 row_ror:8 row_mask:0xf bank_mask:0xf
    v_add_f32_dpp v41, v41, v41 row_ror:8 row_mask:0xf bank_mask:0xf
    v_add_f32_dpp v42, v42, v42 row_ror:8 row_mask:0xf bank_mask:0xf
    v_add_f32_dpp v43, v43, v43 row_ror:8 row_mask:0xf bank_mask:0xf
    v_add_f32_dpp v40, v40, v40 row_ror:4 row_mask:0xf bank_mask:0xf
    v_add_f32_dpp v41, v41, v41 row_ror:4 row_mask:0xf bank_mask:0xf
    v_add_f32_dpp v42, v42, v42 row_ror:4 row_mask:0xf bank_mask:0xf
    v_add_f32_dpp v43, v43, v43 row_ror:4 row_mask:0xf bank_mask:0xf
    v_add_f32_dpp v40, v40, v40 row_ror:2 row_mask:0xf bank_mask:0xf
    v_add_f32_dpp v41, v41, v41 row_ror:2 row_mask:0xf bank_mask:0xf
    v_add_f32_dpp v42, v42, v42 row_ror:2 row_mask:0xf bank_mask:0xf
    v_add_f32_dpp v43, v43, v43 row_ror:2 row_mask:0xf bank_mask:0xf
    v_add_f32_dpp v40, v40, v40 row_ror:1 row_mask:0xf bank_mask:0xf
    v_add_f32_dpp v41, v41, v41 row_ror:1 row_mask:0xf bank_mask:0xf
    v_add_f32_dpp v42, v42, v42 row_ror:1 row_mask:0xf bank_mask:0xf
    v_add_f32_dpp v43, v43, v43 row_ror:1 row_mask:0xf bank_mask:0xf
    v_mov_b32 v44, v40
    v_mov_b32 v45, v41
    v_mov_b32 v46, v42
    v_mov_b32 v47, v43
    v_permlane16_swap_b32 v40, v44
    v_permlane16_swap_b32 v41, v45
    v_permlane16_swap_b32 v42, v46
    v_permlane16_swap_b32 v43, v47
    v_add_f32 v40, v40, v44
    v_add_f32 v41, v41, v45
    v_add_f32 v42, v42, v46
    v_add_f32 v43, v43, v47
    v_mov_b32 v44, v40
    v_mov_b32 v45, v41
    v_mov_b32 v46, v42
    v_mov_b32 v47, v43
    v_permlane32_swap_b32 v40, v44
    v_permlane32_swap_b32 v41, v45
    v_permlane32_swap_b32 v42, v46
    v_permlane32_swap_b32 v43, v47
    v_add_f32 v40, v40, v44
    v_add_f32 v41, v41, v45
    v_add_f32 v42, v42, v46
    v_add_f32 v43, v43, v47
    v_cvt_pk_bf16_f32 v48, v40, v41
    v_lshlrev_b32 v40, 16, v48
    v_and_b32 v41, 0xffff0000, v48
    v_cvt_pk_bf16_f32 v49, v42, v43
    v_lshlrev_b32 v42, 16, v49
    v_and_b32 v43, 0xffff0000, v49
    v_fma_f32 v40, v32, v40, v24
    v_fma_f32 v41, v33, v41, v25
    v_fma_f32 v42, v34, v42, v26
    v_fma_f32 v43, v35, v43, v27
    v_cvt_pk_bf16_f32 v40, v40, v41
    v_cvt_pk_bf16_f32 v41, v42, v43
    s_mov_b64 exec, 1
    buffer_store_dwordx2 v[40:41], v20, s[52:55], 0 offen
    s_sub_u32 s41, s38, 4
    s_or_b32 s41, s40, s41
    s_cmp_eq_u32 s41, 0
    s_cbranch_scc0 L_ep_48
    v_mov_b32 v42, s39
    v_mov_b32 v43, 0
    buffer_store_dword v42, v43, s[60:63], 0 offen sc1
L_ep_48:
    s_mov_b64 exec, -1
L_gc_done:
    s_endpgm
L_end:
    s_endpgm
L_code_end:

.section .rodata,"a"
.p2align 6
.amdhsa_kernel adaLN_cond__sliding_block_cached__glu_gated_bilinear__decode_kernel
  .amdhsa_next_free_vgpr 192
  .amdhsa_next_free_sgpr 102
  .amdhsa_accum_offset 192
  .amdhsa_group_segment_fixed_size 0
  .amdhsa_kernarg_size 112
  .amdhsa_user_sgpr_count 2
  .amdhsa_user_sgpr_kernarg_segment_ptr 1
  .amdhsa_system_sgpr_workgroup_id_x 1
  .amdhsa_float_denorm_mode_32 3
.end_amdhsa_kernel
```
